```python
import torch

def _softmax(x, axis=-1):
    return torch.softmax(x, dim=axis)
def _gelu(x):
    return torch.nn.functional.gelu(x, approximate="tanh")
def _silu(x):
    return torch.nn.functional.silu(x)
def _sigmoid(x):
    return torch.sigmoid(x)
def _layernorm(x, axis=-1, eps=1e-5):
    m = x.mean(dim=axis, keepdim=True)
    v = x.var(dim=axis, keepdim=True, unbiased=False)
    return (x - m) / torch.sqrt(v + eps)
def _scatter_add(tgt, idx, src, axis=0):
    return tgt.clone().index_add_(axis, idx, src)
def _segment_sum(src, seg, n):
    out = torch.zeros((n,) + src.shape[1:], dtype=src.dtype)
    return out.index_add_(0, seg, src)
def _pad(x, pw):
    flat = tuple(v for pair in reversed(pw) for v in pair)
    return torch.nn.functional.pad(x, flat)

kernel_name = 'standalone__gqa_softmax__near_ridge'

def setup_inputs():

    _w = (lambda a: (lambda t: t.to(torch.bfloat16) if t.is_floating_point() else t)(torch.as_tensor(a)))
    B, Hq, Hkv, Sq, Sk, D = 8, 16, 8, 288, 1024, 256
    return {
        "q": _w((lambda *s: torch.randn(*s, dtype=torch.bfloat16) * 0.8)(B, Hq, Sq, D)),
        "k": _w((lambda *s: torch.randn(*s, dtype=torch.bfloat16) * 0.8)(B, Hkv, Sk, D)),
        "v": _w((lambda *s: torch.randn(*s, dtype=torch.bfloat16) * 0.05)(B, Hkv, Sk, D)),
    }

def reference(q, k, v):
    B, Hq, Sq, D = q.shape
    Hkv = k.shape[1]
    rep = Hq // Hkv
    k = (lambda x, n, axis: torch.repeat_interleave(x, n, dim=axis))(k, rep, axis=1)
    v = (lambda x, n, axis: torch.repeat_interleave(x, n, dim=axis))(v, rep, axis=1)
    scale = D ** -0.5
    scores = torch.einsum("bhqd,bhkd->bhqk", q, k) * scale
    p = _softmax(scores, axis=-1)
    return torch.einsum("bhqk,bhkd->bhqd", p, v)
```

```asm
; @launch grid=(256,1,1) block=(256,1,1) lds=163840
.amdgcn_target "amdgcn-amd-amdhsa--gfx950"
.text
.globl standalone__gqa_softmax__near_ridge_kernel
.p2align 8
.type standalone__gqa_softmax__near_ridge_kernel,@function
standalone__gqa_softmax__near_ridge_kernel:
    s_cmp_ge_u32 s2, 256
    s_cbranch_scc1 L_end
    s_load_dwordx4 s[4:7], s[0:1], 0
    s_load_dwordx4 s[36:39], s[0:1], 16
    s_getpc_b64 s[52:53]
L_pc:
    s_bfe_u32 s54, s2, 0x30003
    s_lshl_b32 s54, s54, 12
    v_lshl_add_u32 v1, v0, 4, s54
    v_min_u32 v25, (L_codeend-L_pc-16)&-4, v1
    global_load_dwordx4 v[72:75], v25, s[52:53]
    v_lshrrev_b32 v1, 6, v0
    v_and_b32 v22, 63, v0
    v_readfirstlane_b32 s24, v1
    s_and_b32 s40, s2, 7
    s_lshr_b32 s41, s2, 5
    s_lshl_b32 s41, s41, 3
    s_add_u32 s40, s40, s41
    s_lshr_b32 s41, s2, 3
    s_and_b32 s41, s41, 3
    s_mul_i32 s42, s40, 294912
    s_mul_i32 s44, s41, 73728
    s_add_u32 s48, s42, s44
    s_lshl_b32 s49, s40, 19
    v_lshlrev_b32 v2, 4, v22
    s_mul_i32 s84, s24, 4160
    s_lshl_b32 s31, s84, 1
    s_lshr_b32 s32, s24, 1
    s_and_b32 s33, s24, 1
    s_xor_b32 s34, s32, s33
    s_lshl_b32 s86, s32, 15
    s_lshl_b32 s87, s33, 12
    s_add_u32 s86, s86, s87
    s_mov_b32 s29, 0x3db8aa3b
    s_mov_b32 s30, 0
    s_mov_b32 s11, 0x20000
    s_mov_b32 s23, 0x20000
    s_mov_b32 s10, 73728
    s_mov_b32 s22, 73728
    v_bfe_u32 v92, v22, 2, 1
    v_bfe_u32 v93, v22, 3, 1
    v_lshl_add_u32 v92, v92, 1, v93
    v_and_b32 v93, 3, v22
    v_lshl_add_u32 v97, v93, 2, v92
    v_lshrrev_b32 v94, 4, v22
    v_mul_u32_u24 v96, 1040, v97
    v_lshl_add_u32 v96, v94, 7, v96
    s_mul_i32 s40, s33, 16640
    s_lshl_b32 s41, s32, 9
    s_xor_b32 s42, s41, 512
    s_sub_u32 s43, 16640, s40
    s_add_u32 s44, s40, s41
    s_add_u32 s45, s40, s42
    s_add_u32 s46, s43, s41
    s_add_u32 s47, s43, s42
    v_add_u32 v96, 87040, v96
    v_add_u32 v0, s44, v96
    v_add_u32 v1, s45, v96
    s_add_u32 s87, s86, 8192
    s_mov_b32 s91, 8192
    s_add_u32 s88, s86, 16384
    s_mov_b32 s92, 16384
    s_add_u32 s89, s86, 24576
    s_mov_b32 s93, 24576
    s_lshl_b32 s90, s24, 11
    s_add_u32 s90, s90, 65536
    s_lshr_b32 s85, s84, 1
    v_and_b32 v92, 7, v22
    v_bfe_u32 v95, v22, 3, 1
    v_lshl_add_u32 v97, v92, 1, v95
    v_mul_u32_u24 v99, 1040, v92
    v_lshl_add_u32 v99, v95, 9, v99
    v_lshl_add_u32 v99, v94, 7, v99
    s_mul_i32 s40, s32, 8320
    s_add_u32 s40, s40, 20480
    v_add_u32 v23, s40, v99
    v_add_u32 v24, 0, v99
    v_bfe_u32 v92, v22, 4, 1
    v_bfe_u32 v95, v22, 5, 1
    v_lshl_add_u32 v92, v92, 1, v95
    v_and_b32 v95, 12, v22
    v_add_u32 v92, v92, v95
    v_mul_u32_u24 v95, 1040, v92
    v_lshl_add_u32 v95, v93, 3, v95
    s_lshl_b32 s40, s34, 8
    s_add_u32 s40, s40, 20480
    v_add_u32 v95, s40, v95
    s_lshl_b32 s40, s32, 7
    s_xor_b32 s41, s40, 128
    v_add_u32 v100, s40, v95
    v_add_u32 v101, s41, v95
    v_add_u32 v4, s44, v100
    v_add_u32 v5, s44, v101
    v_add_u32 v6, s45, v100
    v_add_u32 v7, s45, v101
    v_add_u32 v8, s46, v100
    v_add_u32 v9, s46, v101
    v_add_u32 v10, s47, v100
    v_add_u32 v11, s47, v101
    s_xor_b32 s40, s24, 0
    s_mul_i32 s25, s40, 5120
    v_lshl_add_u32 v12, v22, 2, s25
    s_xor_b32 s40, s24, 1
    s_mul_i32 s57, s40, 5120
    v_lshl_add_u32 v13, v22, 2, s57
    s_xor_b32 s40, s24, 2
    s_mul_i32 s58, s40, 5120
    v_lshl_add_u32 v14, v22, 2, s58
    s_xor_b32 s40, s24, 3
    s_mul_i32 s59, s40, 5120
    v_lshl_add_u32 v15, v22, 2, s59
    s_mul_i32 s40, s24, 4352
    s_add_u32 s40, s40, 120320
    v_mul_u32_u24 v16, 272, v97
    v_lshl_add_u32 v16, v94, 3, v16
    v_add_u32 v16, s40, v16
    v_and_b32 v93, 15, v22
    v_lshlrev_b32 v93, 4, v93
    v_mul_u32_u24 v17, 1088, v94
    v_add3_u32 v17, v17, v93, s40
    s_lshl_b32 s41, s32, 15
    s_lshl_b32 s42, s34, 8
    s_add_u32 s41, s41, s42
    s_lshl_b32 s43, s32, 7
    v_xor_b32 v93, s43, v93
    v_lshl_add_u32 v19, v94, 11, v93
    v_add_u32 v19, s41, v19
    v_lshrrev_b32 v92, 3, v22
    v_and_b32 v93, 7, v22
    v_lshlrev_b32 v93, 4, v93
    v_mul_u32_u24 v18, 544, v92
    v_add3_u32 v18, v18, v93, s40
    s_lshl_b32 s41, s32, 7
    s_add_u32 s41, s41, s42
    s_add_u32 s41, s41, 65536
    v_lshl_add_u32 v20, v92, 10, v93
    v_add_u32 v20, s41, v20
    s_mov_b32 s50, 0x53800000
    s_mov_b32 s51, 0x2b800000
    s_bfe_u32 s40, s2, 0x20003
    s_lshl_b32 s40, s40, 2
    s_add_u32 s40, s40, s24
    s_mul_i32 s40, s40, 1024
    v_lshrrev_b32 v3, 3, v22
    v_lshl_add_u32 v3, v3, 7, s40
    s_lshl_b32 s40, s24, 11
    s_add_u32 s40, s40, 155648
    v_add_u32 v21, s40, v2
    s_lshl_b32 s40, s32, 15
    s_lshl_b32 s41, s34, 8
    s_add_u32 s40, s40, s41
    s_lshl_b32 s41, s32, 7
    s_add_u32 s94, s40, s41
    s_xor_b32 s95, s94, 128
    s_add_u32 s96, s94, 8192
    s_add_u32 s97, s95, 8192
    s_add_u32 s98, s96, 8192
    s_add_u32 s99, s97, 8192
    s_add_u32 s100, s98, 8192
    s_add_u32 s101, s99, 8192
    v_bfe_u32 v92, v22, 4, 1
    v_lshrrev_b32 v93, 5, v22
    v_lshlrev_b32 v92, 5, v92
    v_lshl_add_u32 v92, v93, 4, v92
    v_lshl_add_u32 v22, v97, 9, v92
    v_mov_b32 v31, 0
    v_mov_b32 v32, 0
    v_mov_b32 v33, 0
    v_mov_b32 v34, 0
    v_mov_b32 v35, 0
    s_waitcnt lgkmcnt(0)
    s_add_u32 s12, s6, s49
    s_addc_u32 s13, s7, 0
    s_add_u32 s8, s4, s48
    s_addc_u32 s9, s5, 0
    s_add_u32 s16, s36, s49
    s_addc_u32 s17, s37, 0
    s_add_u32 s20, s38, s48
    s_addc_u32 s21, s39, 0
L_restart:
    s_lshl_b32 s40, s24, 13
    s_add_u32 s40, s40, 4096
    s_add_u32 s14, s12, s40
    s_addc_u32 s15, s13, 0
    s_add_u32 s18, s16, s40
    s_addc_u32 s19, s17, 0
    s_add_u32 s26, s14, 524288
    s_add_u32 m0, s84, 20480
    s_nop 0
    buffer_load_dwordx4 v2, s[8:11], s86 offen offset:0 nt lds
    s_add_u32 m0, s31, 91136
    s_nop 0
    global_load_lds_dwordx4 v2, s[14:15] offset:-4096 nt
    s_add_u32 s52, s18, 491520
    s_addc_u32 s53, s19, 0
    s_add_u32 s36, s12, 491520
    s_addc_u32 s37, s13, 0
    s_mov_b32 s38, 131072
    s_mov_b32 s39, 0x20000
    s_add_u32 s4, s16, 393216
    s_addc_u32 s5, s17, 0
    s_mov_b32 s35, 0xffff8000
    v_mov_b32 v128, 0
    v_mov_b32 v129, 0
    v_mov_b32 v130, 0
    v_mov_b32 v131, 0
    v_mov_b32 v132, 0
    v_mov_b32 v133, 0
    v_mov_b32 v134, 0
    v_mov_b32 v135, 0
    v_mov_b32 v136, 0
    v_mov_b32 v137, 0
    v_mov_b32 v138, 0
    v_mov_b32 v139, 0
    v_mov_b32 v140, 0
    v_mov_b32 v141, 0
    v_mov_b32 v142, 0
    v_mov_b32 v143, 0
    v_mov_b32 v144, 0
    v_mov_b32 v145, 0
    v_mov_b32 v146, 0
    v_mov_b32 v147, 0
    v_mov_b32 v148, 0
    v_mov_b32 v149, 0
    v_mov_b32 v150, 0
    v_mov_b32 v151, 0
    v_mov_b32 v152, 0
    v_mov_b32 v153, 0
    v_mov_b32 v154, 0
    v_mov_b32 v155, 0
    v_mov_b32 v156, 0
    v_mov_b32 v157, 0
    v_mov_b32 v158, 0
    v_mov_b32 v159, 0
    v_mov_b32 v160, 0
    v_mov_b32 v161, 0
    v_mov_b32 v162, 0
    v_mov_b32 v163, 0
    v_mov_b32 v164, 0
    v_mov_b32 v165, 0
    v_mov_b32 v166, 0
    v_mov_b32 v167, 0
    v_mov_b32 v168, 0
    v_mov_b32 v169, 0
    v_mov_b32 v170, 0
    v_mov_b32 v171, 0
    v_mov_b32 v172, 0
    v_mov_b32 v173, 0
    v_mov_b32 v174, 0
    v_mov_b32 v175, 0
    v_mov_b32 v176, 0
    v_mov_b32 v177, 0
    v_mov_b32 v178, 0
    v_mov_b32 v179, 0
    v_mov_b32 v180, 0
    v_mov_b32 v181, 0
    v_mov_b32 v182, 0
    v_mov_b32 v183, 0
    v_mov_b32 v184, 0
    v_mov_b32 v185, 0
    v_mov_b32 v186, 0
    v_mov_b32 v187, 0
    v_mov_b32 v188, 0
    v_mov_b32 v189, 0
    v_mov_b32 v190, 0
    v_mov_b32 v191, 0
    v_mov_b32 v36, 0
    v_mov_b32 v37, 0
    v_mov_b32 v38, 0
    v_mov_b32 v39, 0
    v_mov_b32 v40, 0
    v_mov_b32 v41, 0
    v_mov_b32 v42, 0
    v_mov_b32 v43, 0
    v_mov_b32 v44, 0
    v_mov_b32 v45, 0
    v_mov_b32 v46, 0
    v_mov_b32 v47, 0
    v_mov_b32 v48, 0
    v_mov_b32 v49, 0
    v_mov_b32 v50, 0
    v_mov_b32 v51, 0
    v_mov_b32 v26, 0
    v_mov_b32 v27, 0
    v_mov_b32 v28, 0
    v_mov_b32 v29, 0
    v_mov_b32 v30, 0
    s_add_u32 m0, s31, 91152
    s_nop 0
    global_load_lds_dwordx4 v2, s[14:15] offset:-3072 nt
    s_add_u32 m0, s84, 20496
    s_nop 0
    buffer_load_dwordx4 v2, s[8:11], s86 offen offset:1024 nt lds
    s_add_u32 m0, s31, 91168
    s_nop 0
    global_load_lds_dwordx4 v2, s[14:15] offset:-2048 nt
    s_add_u32 m0, s31, 91184
    s_nop 0
    global_load_lds_dwordx4 v2, s[14:15] offset:-1024 nt
    s_add_u32 m0, s84, 20512
    s_nop 0
    buffer_load_dwordx4 v2, s[8:11], s86 offen offset:2048 nt lds
    s_add_u32 m0, s31, 91200
    s_nop 0
    global_load_lds_dwordx4 v2, s[14:15] offset:0 nt
    s_add_u32 m0, s31, 91216
    s_nop 0
    global_load_lds_dwordx4 v2, s[14:15] offset:1024 nt
    s_add_u32 m0, s84, 20528
    s_nop 0
    buffer_load_dwordx4 v2, s[8:11], s86 offen offset:3072 nt lds
    s_add_u32 m0, s31, 91232
    s_nop 0
    global_load_lds_dwordx4 v2, s[14:15] offset:2048 nt
    s_mov_b32 s28, 6
    s_add_u32 m0, s31, 91248
    s_nop 0
    global_load_lds_dwordx4 v2, s[14:15] offset:3072 nt
    s_add_u32 s14, s14, 32768
    s_addc_u32 s15, s15, 0
    s_add_u32 m0, s84, 37120
    s_nop 0
    buffer_load_dwordx4 v2, s[8:11], s87 offen offset:0 nt lds
    s_add_u32 m0, s31, 124416
    s_nop 0
    global_load_lds_dwordx4 v2, s[14:15] offset:-4096 nt
    s_add_u32 m0, s84, 37136
    s_nop 0
    buffer_load_dwordx4 v2, s[8:11], s87 offen offset:1024 nt lds
    s_add_u32 m0, s31, 124432
    s_nop 0
    global_load_lds_dwordx4 v2, s[14:15] offset:-3072 nt
    s_add_u32 m0, s84, 37152
    s_nop 0
    buffer_load_dwordx4 v2, s[8:11], s87 offen offset:2048 nt lds
    s_add_u32 m0, s31, 124448
    s_nop 0
    global_load_lds_dwordx4 v2, s[14:15] offset:-2048 nt
    s_add_u32 m0, s84, 37168
    s_nop 0
    buffer_load_dwordx4 v2, s[8:11], s87 offen offset:3072 nt lds
    s_add_u32 m0, s31, 124464
    s_nop 0
    global_load_lds_dwordx4 v2, s[14:15] offset:-1024 nt
    s_add_u32 m0, s85, 0
    s_nop 0
    buffer_load_dwordx4 v2, s[8:11], s90 offen offset:0 nt lds
    s_add_u32 m0, s31, 124480
    s_nop 0
    global_load_lds_dwordx4 v2, s[14:15] offset:0 nt
    s_add_u32 m0, s31, 124496
    s_nop 0
    global_load_lds_dwordx4 v2, s[14:15] offset:1024 nt
    s_cmp_eq_u32 s24, 0
    s_cbranch_scc1 L_page0
    s_cmp_eq_u32 s24, 1
    s_cbranch_scc1 L_page1
    s_cmp_eq_u32 s24, 2
    s_cbranch_scc1 L_page2
    s_branch L_page3
L_back:
    s_waitcnt vmcnt(11)
    s_barrier
    ds_read_b128 v[192:195], v0 offset:0
    ds_read_b128 a[0:3], v23 offset:0
    ds_read_b128 v[196:199], v0 offset:16
    ds_read_b128 a[4:7], v23 offset:16
    ds_read_b128 v[200:203], v0 offset:32
    ds_read_b128 a[8:11], v23 offset:32
    ds_read_b128 v[204:207], v0 offset:48
    ds_read_b128 a[12:15], v23 offset:48
    ds_read_b128 v[208:211], v0 offset:64
    s_waitcnt lgkmcnt(7)
    v_mfma_f32_16x16x32_bf16 v[92:95], v[192:195], a[0:3], 0
    s_waitcnt lgkmcnt(5)
    ds_read_b128 a[16:19], v23 offset:64
    ds_read_b128 v[212:215], v0 offset:80
    v_mfma_f32_16x16x32_bf16 v[92:95], v[196:199], a[4:7], v[92:95]
    s_waitcnt lgkmcnt(5)
    ds_read_b128 a[20:23], v23 offset:80
    ds_read_b128 v[216:219], v0 offset:96
    v_mfma_f32_16x16x32_bf16 v[92:95], v[200:203], a[8:11], v[92:95]
    s_waitcnt lgkmcnt(5)
    ds_read_b128 a[24:27], v23 offset:96
    ds_read_b128 v[220:223], v0 offset:112
    v_mfma_f32_16x16x32_bf16 v[92:95], v[204:207], a[12:15], v[92:95]
    s_waitcnt lgkmcnt(5)
    ds_read_b128 a[28:31], v23 offset:112
    ds_read_b128 v[224:227], v1 offset:0
    v_mfma_f32_16x16x32_bf16 v[92:95], v[208:211], a[16:19], v[92:95]
    s_waitcnt lgkmcnt(5)
    ds_read_b128 v[228:231], v1 offset:16
    ds_read_b128 v[232:235], v1 offset:32
    v_mfma_f32_16x16x32_bf16 v[92:95], v[212:215], a[20:23], v[92:95]
    ds_read_b128 v[236:239], v1 offset:48
    s_add_u32 m0, s85, 16
    s_nop 0
    buffer_load_dwordx4 v2, s[8:11], s90 offen offset:1024 nt lds
    s_waitcnt lgkmcnt(6)
    v_mfma_f32_16x16x32_bf16 v[92:95], v[216:219], a[24:27], v[92:95]
    ds_read_b128 v[240:243], v1 offset:64
    ds_read_b128 v[244:247], v1 offset:80
    ds_read_b128 v[248:251], v1 offset:96
    s_waitcnt lgkmcnt(7)
    v_mfma_f32_16x16x32_bf16 v[92:95], v[220:223], a[28:31], v[92:95]
    s_waitcnt lgkmcnt(6)
    ds_read_b128 v[252:255], v1 offset:112
    v_mfma_f32_16x16x32_bf16 v[112:115], v[224:227], a[0:3], 0
    s_waitcnt lgkmcnt(6)
    v_mfma_f32_16x16x32_bf16 v[112:115], v[228:231], a[4:7], v[112:115]
    s_waitcnt lgkmcnt(5)
    v_mfma_f32_16x16x32_bf16 v[112:115], v[232:235], a[8:11], v[112:115]
    s_waitcnt lgkmcnt(4)
    v_mfma_f32_16x16x32_bf16 v[112:115], v[236:239], a[12:15], v[112:115]
    s_add_u32 m0, s31, 124512
    s_waitcnt lgkmcnt(3)
    v_mfma_f32_16x16x32_bf16 v[112:115], v[240:243], a[16:19], v[112:115]
    global_load_lds_dwordx4 v2, s[14:15] offset:2048 nt
    s_waitcnt lgkmcnt(2)
    v_mfma_f32_16x16x32_bf16 v[112:115], v[244:247], a[20:23], v[112:115]
    s_waitcnt lgkmcnt(1)
    v_fma_f32 v92, v92, s29, -v31
    v_fma_f32 v93, v93, s29, -v31
    v_mfma_f32_16x16x32_bf16 v[112:115], v[248:251], a[24:27], v[112:115]
    s_waitcnt lgkmcnt(0)
    v_fma_f32 v94, v94, s29, -v31
    v_fma_f32 v95, v95, s29, -v31
    v_mfma_f32_16x16x32_bf16 v[112:115], v[252:255], a[28:31], v[112:115]
    v_exp_f32 v92, v92
    v_exp_f32 v93, v93
    v_exp_f32 v94, v94
    v_exp_f32 v95, v95
    v_cvt_pk_bf16_f32 v52, v92, v93
    v_cvt_pk_bf16_f32 v53, v94, v95
    v_add_f32 v26, v26, v92
    v_add_f32 v26, v26, v93
    v_fma_f32 v112, v112, s29, -v31
    v_fma_f32 v113, v113, s29, -v31
    v_fma_f32 v114, v114, s29, -v31
    v_fma_f32 v115, v115, s29, -v31
    v_exp_f32 v112, v112
    v_exp_f32 v113, v113
    v_exp_f32 v114, v114
    v_exp_f32 v115, v115
    v_cvt_pk_bf16_f32 v54, v112, v113
    v_cvt_pk_bf16_f32 v55, v114, v115
    v_add_f32 v26, v26, v94
    v_add_f32 v26, v26, v95
    v_add_f32 v26, v26, v112
    v_add_f32 v26, v26, v113
    v_add_f32 v26, v26, v114
    v_add_f32 v26, v26, v115
    s_add_u32 m0, s31, 124528
    s_nop 0
    global_load_lds_dwordx4 v2, s[14:15] offset:3072 nt
    s_add_u32 s14, s14, 32768
    s_addc_u32 s15, s15, 0
    s_add_u32 m0, s84, 53760
    s_nop 0
    buffer_load_dwordx4 v2, s[8:11], s88 offen offset:0 nt lds
    s_add_u32 m0, s84, 53776
    s_nop 0
    buffer_load_dwordx4 v2, s[8:11], s88 offen offset:1024 nt lds
    s_add_u32 m0, s84, 53792
    s_nop 0
    buffer_load_dwordx4 v2, s[8:11], s88 offen offset:2048 nt lds
    s_add_u32 m0, s84, 53808
    s_nop 0
    buffer_load_dwordx4 v2, s[8:11], s88 offen offset:3072 nt lds
    s_branch L_cont
.p2align 12
L_page3:
s_branch L_back
L_cont:
    s_waitcnt vmcnt(11)
    s_barrier
    ds_read_b128 a[32:35], v23 offset:16640
    ds_read_b128 a[36:39], v23 offset:16656
    ds_read_b128 a[40:43], v23 offset:16672
    ds_read_b128 a[44:47], v23 offset:16688
    ds_read_b128 a[48:51], v23 offset:16704
    ds_read_b128 a[52:55], v23 offset:16720
    ds_read_b128 a[56:59], v23 offset:16736
    ds_read_b128 a[60:63], v23 offset:16752
    s_waitcnt lgkmcnt(7)
    v_mfma_f32_16x16x32_bf16 v[96:99], v[192:195], a[32:35], 0
    s_waitcnt lgkmcnt(6)
    v_mfma_f32_16x16x32_bf16 v[96:99], v[196:199], a[36:39], v[96:99]
    s_add_u32 m0, s84, 70400
    s_waitcnt lgkmcnt(5)
    v_mfma_f32_16x16x32_bf16 v[96:99], v[200:203], a[40:43], v[96:99]
    buffer_load_dwordx4 v2, s[8:11], s89 offen offset:0 nt lds
    s_waitcnt lgkmcnt(4)
    v_mfma_f32_16x16x32_bf16 v[96:99], v[204:207], a[44:47], v[96:99]
    s_waitcnt lgkmcnt(3)
    v_mfma_f32_16x16x32_bf16 v[96:99], v[208:211], a[48:51], v[96:99]
    s_waitcnt lgkmcnt(2)
    v_mfma_f32_16x16x32_bf16 v[96:99], v[212:215], a[52:55], v[96:99]
    s_waitcnt lgkmcnt(1)
    v_mfma_f32_16x16x32_bf16 v[96:99], v[216:219], a[56:59], v[96:99]
    s_waitcnt lgkmcnt(0)
    v_mfma_f32_16x16x32_bf16 v[96:99], v[220:223], a[60:63], v[96:99]
    v_mfma_f32_16x16x32_bf16 v[116:119], v[224:227], a[32:35], 0
    v_mfma_f32_16x16x32_bf16 v[116:119], v[228:231], a[36:39], v[116:119]
    v_mfma_f32_16x16x32_bf16 v[116:119], v[232:235], a[40:43], v[116:119]
    v_mfma_f32_16x16x32_bf16 v[116:119], v[236:239], a[44:47], v[116:119]
    v_mfma_f32_16x16x32_bf16 v[116:119], v[240:243], a[48:51], v[116:119]
    v_mfma_f32_16x16x32_bf16 v[116:119], v[244:247], a[52:55], v[116:119]
    s_nop 1
    v_fma_f32 v96, v96, s29, -v32
    v_mfma_f32_16x16x32_bf16 v[116:119], v[248:251], a[56:59], v[116:119]
    v_fma_f32 v97, v97, s29, -v32
    v_fma_f32 v98, v98, s29, -v32
    v_mfma_f32_16x16x32_bf16 v[116:119], v[252:255], a[60:63], v[116:119]
    v_fma_f32 v99, v99, s29, -v32
    v_exp_f32 v96, v96
    v_exp_f32 v97, v97
    v_exp_f32 v98, v98
    v_exp_f32 v99, v99
    v_cvt_pk_bf16_f32 v56, v96, v97
    v_cvt_pk_bf16_f32 v57, v98, v99
    v_add_f32 v27, v27, v96
    v_fma_f32 v116, v116, s29, -v32
    v_fma_f32 v117, v117, s29, -v32
    v_fma_f32 v118, v118, s29, -v32
    v_fma_f32 v119, v119, s29, -v32
    v_exp_f32 v116, v116
    v_exp_f32 v117, v117
    v_exp_f32 v118, v118
    v_exp_f32 v119, v119
    v_cvt_pk_bf16_f32 v58, v116, v117
    v_cvt_pk_bf16_f32 v59, v118, v119
    s_add_u32 m0, s84, 70416
    v_add_f32 v27, v27, v97
    v_add_f32 v27, v27, v98
    v_add_f32 v27, v27, v99
    v_add_f32 v27, v27, v116
    v_add_f32 v27, v27, v117
    v_add_f32 v27, v27, v118
    v_add_f32 v27, v27, v119
    buffer_load_dwordx4 v2, s[8:11], s89 offen offset:1024 nt lds
    s_add_u32 m0, s84, 70432
    s_nop 0
    buffer_load_dwordx4 v2, s[8:11], s89 offen offset:2048 nt lds
    s_add_u32 m0, s84, 70448
    s_nop 0
    buffer_load_dwordx4 v2, s[8:11], s89 offen offset:3072 nt lds
    s_waitcnt vmcnt(8)
    s_barrier
    ds_read_b128 a[128:131], v24 offset:0
    ds_read_b128 a[132:135], v24 offset:16
    ds_read_b128 a[136:139], v24 offset:32
    s_add_u32 m0, s31, 24576
    s_nop 0
    global_load_lds_dwordx4 v2, s[18:19] offset:-4096 nt
    ds_read_b128 a[140:143], v24 offset:48
    s_add_u32 m0, s31, 24592
    ds_read_b128 a[144:147], v24 offset:64
    ds_read_b128 a[148:151], v24 offset:80
    ds_read_b128 a[152:155], v24 offset:96
    global_load_lds_dwordx4 v2, s[18:19] offset:-3072 nt
    s_add_u32 m0, s31, 24608
    s_waitcnt lgkmcnt(6)
    v_mfma_f32_16x16x32_bf16 v[108:111], v[192:195], a[128:131], 0
    s_waitcnt lgkmcnt(5)
    ds_read_b128 a[156:159], v24 offset:112
    v_mfma_f32_16x16x32_bf16 v[108:111], v[196:199], a[132:135], v[108:111]
    s_waitcnt lgkmcnt(5)
    ds_read_b128 a[192:195], v0 offset:33280
    v_mfma_f32_16x16x32_bf16 v[108:111], v[200:203], a[136:139], v[108:111]
    s_waitcnt lgkmcnt(5)
    ds_read_b128 a[196:199], v0 offset:33296
    v_mfma_f32_16x16x32_bf16 v[108:111], v[204:207], a[140:143], v[108:111]
    global_load_lds_dwordx4 v2, s[18:19] offset:-2048 nt
    s_waitcnt lgkmcnt(5)
    v_mfma_f32_16x16x32_bf16 v[108:111], v[208:211], a[144:147], v[108:111]
    s_waitcnt lgkmcnt(4)
    ds_read_b128 a[200:203], v0 offset:33312
    v_mfma_f32_16x16x32_bf16 v[108:111], v[212:215], a[148:151], v[108:111]
    s_waitcnt lgkmcnt(4)
    ds_read_b128 a[204:207], v0 offset:33328
    v_mfma_f32_16x16x32_bf16 v[108:111], v[216:219], a[152:155], v[108:111]
    s_waitcnt lgkmcnt(4)
    ds_read_b128 a[208:211], v0 offset:33344
    v_mfma_f32_16x16x32_bf16 v[108:111], v[220:223], a[156:159], v[108:111]
    ds_read_b128 a[212:215], v0 offset:33360
    ds_read_b128 a[216:219], v0 offset:33376
    ds_read_b128 a[220:223], v0 offset:33392
    s_waitcnt lgkmcnt(7)
    v_mfma_f32_16x16x32_bf16 v[92:95], a[192:195], a[0:3], 0
    s_waitcnt lgkmcnt(6)
    ds_read_b128 a[224:227], v1 offset:33280
    v_mfma_f32_16x16x32_bf16 v[92:95], a[196:199], a[4:7], v[92:95]
    ds_read_b128 a[228:231], v1 offset:33296
    v_fma_f32 v108, v108, s29, -v35
    v_fma_f32 v109, v109, s29, -v35
    v_fma_f32 v110, v110, s29, -v35
    v_fma_f32 v111, v111, s29, -v35
    v_exp_f32 v108, v108
    ds_read_b128 a[232:235], v1 offset:33312
    ds_read_b128 a[236:239], v1 offset:33328
    v_exp_f32 v109, v109
    ds_read_b128 a[240:243], v1 offset:33344
    v_exp_f32 v110, v110
    v_exp_f32 v111, v111
    ds_read_b128 a[244:247], v1 offset:33360
    v_cvt_pk_bf16_f32 v68, v108, v109
    v_cvt_pk_bf16_f32 v69, v110, v111
    s_add_u32 m0, s31, 24624
    ds_read_b128 a[248:251], v1 offset:33376
    global_load_lds_dwordx4 v2, s[18:19] offset:-1024 nt
    ds_read_b128 a[252:255], v1 offset:33392
    v_add_f32 v30, v30, v108
    s_waitcnt lgkmcnt(8)
    v_mfma_f32_16x16x32_bf16 v[92:95], a[200:203], a[8:11], v[92:95]
    v_add_f32 v30, v30, v109
    v_add_f32 v30, v30, v110
    v_mfma_f32_16x16x32_bf16 v[92:95], a[204:207], a[12:15], v[92:95]
    v_add_f32 v30, v30, v111
    v_mfma_f32_16x16x32_bf16 v[92:95], a[208:211], a[16:19], v[92:95]
    v_mfma_f32_16x16x32_bf16 v[92:95], a[212:215], a[20:23], v[92:95]
    v_mfma_f32_16x16x32_bf16 v[92:95], a[216:219], a[24:27], v[92:95]
    v_mfma_f32_16x16x32_bf16 v[92:95], a[220:223], a[28:31], v[92:95]
    s_waitcnt lgkmcnt(4)
    v_mfma_f32_16x16x32_bf16 v[112:115], a[224:227], a[0:3], 0
    v_mfma_f32_16x16x32_bf16 v[112:115], a[228:231], a[4:7], v[112:115]
    v_mfma_f32_16x16x32_bf16 v[112:115], a[232:235], a[8:11], v[112:115]
    v_mfma_f32_16x16x32_bf16 v[112:115], a[236:239], a[12:15], v[112:115]
    s_waitcnt lgkmcnt(2)
    v_mfma_f32_16x16x32_bf16 v[112:115], a[240:243], a[16:19], v[112:115]
    v_mfma_f32_16x16x32_bf16 v[112:115], a[244:247], a[20:23], v[112:115]
    s_waitcnt lgkmcnt(0)
    v_fma_f32 v92, v92, s29, -v31
    v_mfma_f32_16x16x32_bf16 v[112:115], a[248:251], a[24:27], v[112:115]
    v_fma_f32 v93, v93, s29, -v31
    v_fma_f32 v94, v94, s29, -v31
    v_mfma_f32_16x16x32_bf16 v[112:115], a[252:255], a[28:31], v[112:115]
    v_fma_f32 v95, v95, s29, -v31
    s_add_u32 m0, s31, 24640
    v_mfma_f32_16x16x32_bf16 v[96:99], a[192:195], a[32:35], 0
    global_load_lds_dwordx4 v2, s[18:19] offset:0 nt
    v_mfma_f32_16x16x32_bf16 v[96:99], a[196:199], a[36:39], v[96:99]
    v_exp_f32 v92, v92
    v_mfma_f32_16x16x32_bf16 v[96:99], a[200:203], a[40:43], v[96:99]
    v_exp_f32 v93, v93
    v_mfma_f32_16x16x32_bf16 v[96:99], a[204:207], a[44:47], v[96:99]
    v_exp_f32 v94, v94
    v_mfma_f32_16x16x32_bf16 v[96:99], a[208:211], a[48:51], v[96:99]
    v_exp_f32 v95, v95
    v_mfma_f32_16x16x32_bf16 v[96:99], a[212:215], a[52:55], v[96:99]
    v_add_f32 v26, v26, v92
    v_add_f32 v26, v26, v93
    v_mfma_f32_16x16x32_bf16 v[96:99], a[216:219], a[56:59], v[96:99]
    v_cvt_pk_bf16_f32 v72, v92, v93
    v_add_f32 v26, v26, v94
    v_mfma_f32_16x16x32_bf16 v[96:99], a[220:223], a[60:63], v[96:99]
    v_add_f32 v26, v26, v95
    v_cvt_pk_bf16_f32 v73, v94, v95
    v_mfma_f32_16x16x32_bf16 v[116:119], a[224:227], a[32:35], 0
    v_mfma_f32_16x16x32_bf16 v[116:119], a[228:231], a[36:39], v[116:119]
    v_mfma_f32_16x16x32_bf16 v[116:119], a[232:235], a[40:43], v[116:119]
    v_mfma_f32_16x16x32_bf16 v[116:119], a[236:239], a[44:47], v[116:119]
    s_nop 1
    v_fma_f32 v96, v96, s29, -v32
    v_mfma_f32_16x16x32_bf16 v[116:119], a[240:243], a[48:51], v[116:119]
    v_fma_f32 v97, v97, s29, -v32
    v_fma_f32 v98, v98, s29, -v32
    v_mfma_f32_16x16x32_bf16 v[116:119], a[244:247], a[52:55], v[116:119]
    v_fma_f32 v99, v99, s29, -v32
    v_mfma_f32_16x16x32_bf16 v[116:119], a[248:251], a[56:59], v[116:119]
    v_exp_f32 v96, v96
    v_mfma_f32_16x16x32_bf16 v[116:119], a[252:255], a[60:63], v[116:119]
    v_exp_f32 v97, v97
    v_mfma_f32_16x16x32_bf16 v[108:111], a[192:195], a[128:131], 0
    v_exp_f32 v98, v98
    v_mfma_f32_16x16x32_bf16 v[108:111], a[196:199], a[132:135], v[108:111]
    v_exp_f32 v99, v99
    v_mfma_f32_16x16x32_bf16 v[108:111], a[200:203], a[136:139], v[108:111]
    s_add_u32 m0, s31, 24656
    v_add_f32 v27, v27, v96
    v_mfma_f32_16x16x32_bf16 v[108:111], a[204:207], a[140:143], v[108:111]
    global_load_lds_dwordx4 v2, s[18:19] offset:1024 nt
    v_mfma_f32_16x16x32_bf16 v[108:111], a[208:211], a[144:147], v[108:111]
    v_add_f32 v27, v27, v97
    v_cvt_pk_bf16_f32 v76, v96, v97
    v_mfma_f32_16x16x32_bf16 v[108:111], a[212:215], a[148:151], v[108:111]
    v_add_f32 v27, v27, v98
    v_add_f32 v27, v27, v99
    v_mfma_f32_16x16x32_bf16 v[108:111], a[216:219], a[152:155], v[108:111]
    v_cvt_pk_bf16_f32 v77, v98, v99
    v_mfma_f32_16x16x32_bf16 v[108:111], a[220:223], a[156:159], v[108:111]
    s_add_u32 m0, s31, 24672
    s_nop 0
    global_load_lds_dwordx4 v2, s[18:19] offset:2048 nt
    s_waitcnt vmcnt(11)
    s_barrier
    ds_read_b128 a[64:67], v23 offset:33280
    ds_write2st64_b32 v12, v52, v53 offset0:0 offset1:1
    ds_write2st64_b32 v12, v56, v57 offset0:4 offset1:5
    ds_write2st64_b32 v12, v68, v69 offset0:16 offset1:17
    s_waitcnt lgkmcnt(3)
    v_mfma_f32_16x16x32_bf16 v[100:103], v[192:195], a[64:67], 0
    v_mfma_f32_16x16x32_bf16 v[120:123], v[224:227], a[64:67], 0
    ds_read_b128 a[68:71], v23 offset:33296
    ds_write2st64_b32 v12, v54, v55 offset0:2 offset1:3
    ds_write2st64_b32 v12, v58, v59 offset0:6 offset1:7
    ds_read_b128 a[72:75], v23 offset:33312
    ds_read_b128 a[76:79], v23 offset:33328
    ds_read_b128 a[80:83], v23 offset:33344
    s_waitcnt lgkmcnt(5)
    v_mfma_f32_16x16x32_bf16 v[100:103], v[196:199], a[68:71], v[100:103]
    ds_read_b128 a[84:87], v23 offset:33360
    v_mfma_f32_16x16x32_bf16 v[120:123], v[228:231], a[68:71], v[120:123]
    ds_read_b128 a[88:91], v23 offset:33376
    ds_read_b128 a[92:95], v23 offset:33392
    s_add_u32 m0, s31, 24688
    s_nop 0
    global_load_lds_dwordx4 v2, s[18:19] offset:3072 nt
    s_waitcnt lgkmcnt(5)
    v_mfma_f32_16x16x32_bf16 v[100:103], v[200:203], a[72:75], v[100:103]
    s_add_u32 s18, s18, 32768
    s_addc_u32 s19, s19, 0
    s_waitcnt lgkmcnt(4)
    v_mfma_f32_16x16x32_bf16 v[100:103], v[204:207], a[76:79], v[100:103]
    s_waitcnt lgkmcnt(3)
    v_mfma_f32_16x16x32_bf16 v[100:103], v[208:211], a[80:83], v[100:103]
    s_waitcnt lgkmcnt(2)
    v_mfma_f32_16x16x32_bf16 v[100:103], v[212:215], a[84:87], v[100:103]
    s_waitcnt lgkmcnt(1)
    v_mfma_f32_16x16x32_bf16 v[100:103], v[216:219], a[88:91], v[100:103]
    s_waitcnt lgkmcnt(0)
    v_mfma_f32_16x16x32_bf16 v[100:103], v[220:223], a[92:95], v[100:103]
    v_mfma_f32_16x16x32_bf16 v[120:123], v[232:235], a[72:75], v[120:123]
    v_mfma_f32_16x16x32_bf16 v[120:123], v[236:239], a[76:79], v[120:123]
    v_mfma_f32_16x16x32_bf16 v[120:123], v[240:243], a[80:83], v[120:123]
    v_mfma_f32_16x16x32_bf16 v[120:123], v[244:247], a[84:87], v[120:123]
    v_mfma_f32_16x16x32_bf16 v[120:123], v[248:251], a[88:91], v[120:123]
    v_mfma_f32_16x16x32_bf16 v[120:123], v[252:255], a[92:95], v[120:123]
    s_nop 1
    v_fma_f32 v100, v100, s29, -v33
    v_exp_f32 v100, v100
    v_fma_f32 v101, v101, s29, -v33
    v_fma_f32 v102, v102, s29, -v33
    v_fma_f32 v103, v103, s29, -v33
    v_exp_f32 v101, v101
    v_exp_f32 v102, v102
    v_exp_f32 v103, v103
    v_cvt_pk_bf16_f32 v60, v100, v101
    v_cvt_pk_bf16_f32 v61, v102, v103
    ds_write2st64_b32 v12, v60, v61 offset0:8 offset1:9
    v_fma_f32 v120, v120, s29, -v33
    v_fma_f32 v121, v121, s29, -v33
    v_fma_f32 v122, v122, s29, -v33
    v_fma_f32 v123, v123, s29, -v33
    v_exp_f32 v120, v120
    v_exp_f32 v121, v121
    v_exp_f32 v122, v122
    v_exp_f32 v123, v123
    v_cvt_pk_bf16_f32 v62, v120, v121
    v_cvt_pk_bf16_f32 v63, v122, v123
    ds_write2st64_b32 v12, v62, v63 offset0:10 offset1:11
    s_add_u32 m0, s31, 91136
    v_add_f32 v28, v28, v100
    v_add_f32 v28, v28, v101
    v_add_f32 v28, v28, v102
    v_add_f32 v28, v28, v103
    v_mfma_f32_16x16x32_bf16 v[100:103], a[192:195], a[64:67], 0
    global_load_lds_dwordx4 v2, s[14:15] offset:-4096 nt
    v_mfma_f32_16x16x32_bf16 v[100:103], a[196:199], a[68:71], v[100:103]
    v_add_f32 v28, v28, v120
    v_add_f32 v28, v28, v121
    v_mfma_f32_16x16x32_bf16 v[100:103], a[200:203], a[72:75], v[100:103]
    v_add_f32 v28, v28, v122
    v_add_f32 v28, v28, v123
    v_mfma_f32_16x16x32_bf16 v[100:103], a[204:207], a[76:79], v[100:103]
    v_mfma_f32_16x16x32_bf16 v[100:103], a[208:211], a[80:83], v[100:103]
    v_mfma_f32_16x16x32_bf16 v[100:103], a[212:215], a[84:87], v[100:103]
    v_mfma_f32_16x16x32_bf16 v[100:103], a[216:219], a[88:91], v[100:103]
    v_mfma_f32_16x16x32_bf16 v[100:103], a[220:223], a[92:95], v[100:103]
    v_mfma_f32_16x16x32_bf16 v[120:123], a[224:227], a[64:67], 0
    v_mfma_f32_16x16x32_bf16 v[120:123], a[228:231], a[68:71], v[120:123]
    v_mfma_f32_16x16x32_bf16 v[120:123], a[232:235], a[72:75], v[120:123]
    v_mfma_f32_16x16x32_bf16 v[120:123], a[236:239], a[76:79], v[120:123]
    v_mfma_f32_16x16x32_bf16 v[120:123], a[240:243], a[80:83], v[120:123]
    v_mfma_f32_16x16x32_bf16 v[120:123], a[244:247], a[84:87], v[120:123]
    s_nop 1
    v_fma_f32 v100, v100, s29, -v33
    v_mfma_f32_16x16x32_bf16 v[120:123], a[248:251], a[88:91], v[120:123]
    s_add_u32 m0, s31, 91152
    v_fma_f32 v101, v101, s29, -v33
    v_mfma_f32_16x16x32_bf16 v[120:123], a[252:255], a[92:95], v[120:123]
    global_load_lds_dwordx4 v2, s[14:15] offset:-3072 nt
    v_fma_f32 v102, v102, s29, -v33
    v_fma_f32 v103, v103, s29, -v33
    v_exp_f32 v100, v100
    v_exp_f32 v101, v101
    v_exp_f32 v102, v102
    v_exp_f32 v103, v103
    v_add_f32 v28, v28, v100
    v_add_f32 v28, v28, v101
    v_cvt_pk_bf16_f32 v80, v100, v101
    v_add_f32 v28, v28, v102
    v_add_f32 v28, v28, v103
    v_cvt_pk_bf16_f32 v81, v102, v103
    s_add_u32 m0, s31, 91168
    s_nop 0
    global_load_lds_dwordx4 v2, s[14:15] offset:-2048 nt
    s_waitcnt vmcnt(11)
    s_barrier
    ds_read_b128 a[96:99], v23 offset:49920
    ds_read_b128 a[100:103], v23 offset:49936
    ds_read_b128 a[104:107], v23 offset:49952
    ds_read_b128 a[108:111], v23 offset:49968
    ds_read_b128 a[112:115], v23 offset:49984
    ds_read_b128 a[116:119], v23 offset:50000
    ds_read_b128 a[120:123], v23 offset:50016
    ds_read_b128 a[124:127], v23 offset:50032
    s_waitcnt lgkmcnt(7)
    v_mfma_f32_16x16x32_bf16 v[104:107], v[192:195], a[96:99], 0
    v_mov_b32 v192, 0
    s_add_u32 m0, s31, 91184
    s_waitcnt lgkmcnt(6)
    v_mfma_f32_16x16x32_bf16 v[104:107], v[196:199], a[100:103], v[104:107]
    global_load_lds_dwordx4 v2, s[14:15] offset:-1024 nt
    s_waitcnt lgkmcnt(5)
    v_mfma_f32_16x16x32_bf16 v[104:107], v[200:203], a[104:107], v[104:107]
    s_waitcnt lgkmcnt(4)
    v_mov_b32 v193, 0
    v_mov_b32 v194, 0
    v_mfma_f32_16x16x32_bf16 v[104:107], v[204:207], a[108:111], v[104:107]
    s_waitcnt lgkmcnt(3)
    v_mov_b32 v195, 0
    v_mov_b32 v196, 0
    v_mfma_f32_16x16x32_bf16 v[104:107], v[208:211], a[112:115], v[104:107]
    s_waitcnt lgkmcnt(2)
    v_mov_b32 v197, 0
    v_mov_b32 v198, 0
    v_mfma_f32_16x16x32_bf16 v[104:107], v[212:215], a[116:119], v[104:107]
    s_waitcnt lgkmcnt(1)
    v_mov_b32 v199, 0
    v_mov_b32 v200, 0
    v_mfma_f32_16x16x32_bf16 v[104:107], v[216:219], a[120:123], v[104:107]
    s_waitcnt lgkmcnt(0)
    v_mov_b32 v201, 0
    v_mov_b32 v202, 0
    v_mfma_f32_16x16x32_bf16 v[104:107], v[220:223], a[124:127], v[104:107]
    v_mov_b32 v203, 0
    v_mov_b32 v204, 0
    v_mfma_f32_16x16x32_bf16 v[124:127], v[224:227], a[96:99], 0
    v_mov_b32 v205, 0
    v_mov_b32 v206, 0
    v_mfma_f32_16x16x32_bf16 v[124:127], v[228:231], a[100:103], v[124:127]
    s_add_u32 m0, s31, 91200
    v_mov_b32 v207, 0
    v_fma_f32 v104, v104, s29, -v34
    v_mfma_f32_16x16x32_bf16 v[124:127], v[232:235], a[104:107], v[124:127]
    global_load_lds_dwordx4 v2, s[14:15] offset:0 nt
    v_mfma_f32_16x16x32_bf16 v[124:127], v[236:239], a[108:111], v[124:127]
    v_fma_f32 v105, v105, s29, -v34
    v_fma_f32 v106, v106, s29, -v34
    v_mfma_f32_16x16x32_bf16 v[124:127], v[240:243], a[112:115], v[124:127]
    v_fma_f32 v107, v107, s29, -v34
    v_mov_b32 v208, 0
    v_mfma_f32_16x16x32_bf16 v[124:127], v[244:247], a[116:119], v[124:127]
    v_exp_f32 v104, v104
    v_mfma_f32_16x16x32_bf16 v[124:127], v[248:251], a[120:123], v[124:127]
    v_exp_f32 v105, v105
    v_mfma_f32_16x16x32_bf16 v[124:127], v[252:255], a[124:127], v[124:127]
    v_exp_f32 v106, v106
    v_exp_f32 v107, v107
    v_cvt_pk_bf16_f32 v64, v104, v105
    v_cvt_pk_bf16_f32 v65, v106, v107
    ds_write2st64_b32 v12, v64, v65 offset0:12 offset1:13
    s_add_u32 m0, s31, 91216
    v_add_f32 v29, v29, v104
    v_add_f32 v29, v29, v105
    v_fma_f32 v124, v124, s29, -v34
    v_fma_f32 v125, v125, s29, -v34
    v_fma_f32 v126, v126, s29, -v34
    v_fma_f32 v127, v127, s29, -v34
    v_exp_f32 v124, v124
    v_exp_f32 v125, v125
    v_exp_f32 v126, v126
    v_exp_f32 v127, v127
    v_cvt_pk_bf16_f32 v66, v124, v125
    v_cvt_pk_bf16_f32 v67, v126, v127
    ds_write2st64_b32 v12, v66, v67 offset0:14 offset1:15
    global_load_lds_dwordx4 v2, s[14:15] offset:1024 nt
    v_add_f32 v29, v29, v106
    v_add_f32 v29, v29, v107
    v_mfma_f32_16x16x32_bf16 v[104:107], a[192:195], a[96:99], 0
    v_add_f32 v29, v29, v124
    v_add_f32 v29, v29, v125
    s_add_u32 m0, s31, 91232
    v_mfma_f32_16x16x32_bf16 v[104:107], a[196:199], a[100:103], v[104:107]
    v_add_f32 v29, v29, v126
    v_add_f32 v29, v29, v127
    v_mfma_f32_16x16x32_bf16 v[104:107], a[200:203], a[104:107], v[104:107]
    v_mov_b32 v209, 0
    v_mov_b32 v210, 0
    v_mfma_f32_16x16x32_bf16 v[104:107], a[204:207], a[108:111], v[104:107]
    global_load_lds_dwordx4 v2, s[14:15] offset:2048 nt
    v_mfma_f32_16x16x32_bf16 v[104:107], a[208:211], a[112:115], v[104:107]
    v_mov_b32 v211, 0
    v_mov_b32 v212, 0
    v_mfma_f32_16x16x32_bf16 v[104:107], a[212:215], a[116:119], v[104:107]
    v_mov_b32 v213, 0
    v_mov_b32 v214, 0
    v_mfma_f32_16x16x32_bf16 v[104:107], a[216:219], a[120:123], v[104:107]
    v_mov_b32 v215, 0
    v_mov_b32 v216, 0
    v_mfma_f32_16x16x32_bf16 v[104:107], a[220:223], a[124:127], v[104:107]
    v_mov_b32 v217, 0
    v_mov_b32 v218, 0
    v_mfma_f32_16x16x32_bf16 v[124:127], a[224:227], a[96:99], 0
    v_mov_b32 v219, 0
    s_add_u32 m0, s31, 91248
    v_mfma_f32_16x16x32_bf16 v[124:127], a[228:231], a[100:103], v[124:127]
    global_load_lds_dwordx4 v2, s[14:15] offset:3072 nt
    s_add_u32 s14, s14, 32768
    s_addc_u32 s15, s15, 0
    v_mfma_f32_16x16x32_bf16 v[124:127], a[232:235], a[104:107], v[124:127]
    v_fma_f32 v104, v104, s29, -v34
    v_fma_f32 v105, v105, s29, -v34
    v_mfma_f32_16x16x32_bf16 v[124:127], a[236:239], a[108:111], v[124:127]
    v_fma_f32 v106, v106, s29, -v34
    v_mov_b32 v220, 0
    v_mfma_f32_16x16x32_bf16 v[124:127], a[240:243], a[112:115], v[124:127]
    v_exp_f32 v104, v104
    v_mfma_f32_16x16x32_bf16 v[124:127], a[244:247], a[116:119], v[124:127]
    v_exp_f32 v105, v105
    v_mfma_f32_16x16x32_bf16 v[124:127], a[248:251], a[120:123], v[124:127]
    v_exp_f32 v106, v106
    v_mfma_f32_16x16x32_bf16 v[124:127], a[252:255], a[124:127], v[124:127]
    v_add_f32 v29, v29, v104
    v_add_f32 v29, v29, v105
    v_cvt_pk_bf16_f32 v84, v104, v105
    v_mov_b32 v221, 0
    v_mov_b32 v222, 0
    v_mov_b32 v223, 0
    v_mov_b32 v224, 0
    v_mov_b32 v225, 0
    v_mov_b32 v226, 0
    v_mov_b32 v227, 0
    v_mov_b32 v228, 0
    v_mov_b32 v229, 0
    v_mov_b32 v230, 0
    v_mov_b32 v231, 0
    v_mov_b32 v232, 0
    v_mov_b32 v233, 0
    v_mov_b32 v234, 0
    v_mov_b32 v235, 0
    v_mov_b32 v236, 0
    v_mov_b32 v237, 0
    v_mov_b32 v238, 0
    v_mov_b32 v239, 0
    v_mov_b32 v240, 0
    v_mov_b32 v241, 0
    v_mov_b32 v242, 0
    v_mov_b32 v243, 0
    v_mov_b32 v244, 0
    v_mov_b32 v245, 0
    v_mov_b32 v246, 0
    v_mov_b32 v247, 0
    v_mov_b32 v248, 0
    v_mov_b32 v249, 0
    v_mov_b32 v250, 0
    v_mov_b32 v251, 0
    v_mov_b32 v252, 0
    v_mov_b32 v253, 0
    v_mov_b32 v254, 0
    v_mov_b32 v255, 0
    s_waitcnt vmcnt(8) lgkmcnt(0)
    s_barrier
    s_add_u32 m0, s31, 57856
    ds_read_b64_tr_b16 a[192:193], v4 offset:0
    global_load_lds_dwordx4 v2, s[18:19] offset:-4096 nt
    s_add_u32 m0, s31, 57872
    ds_read_b64_tr_b16 a[194:195], v6 offset:0
    ds_read_b64_tr_b16 a[196:197], v8 offset:0
    ds_read_b64_tr_b16 a[198:199], v10 offset:0
    ds_read2st64_b32 a[160:161], v13 offset0:0 offset1:1
    ds_read2st64_b32 a[162:163], v13 offset0:2 offset1:3
    ds_read2st64_b32 a[164:165], v13 offset0:4 offset1:5
    ds_read2st64_b32 a[166:167], v13 offset0:6 offset1:7
    ds_read2st64_b32 a[168:169], v13 offset0:8 offset1:9
    ds_read2st64_b32 a[170:171], v13 offset0:10 offset1:11
    ds_read2st64_b32 a[172:173], v13 offset0:12 offset1:13
    global_load_lds_dwordx4 v2, s[18:19] offset:-3072 nt
    s_add_u32 m0, s31, 57888
    ds_read2st64_b32 a[174:175], v13 offset0:14 offset1:15
    ds_read2st64_b32 v[70:71], v14 offset0:16 offset1:17
    ds_read2st64_b32 a[176:177], v13 offset0:16 offset1:17
    ds_read2st64_b32 a[178:179], v15 offset0:16 offset1:17
    ds_read_b64_tr_b16 a[200:201], v4 offset:32
    ds_read_b64_tr_b16 a[202:203], v6 offset:32
    global_load_lds_dwordx4 v2, s[18:19] offset:-2048 nt
    s_add_u32 m0, s31, 57904
    s_nop 0
    global_load_lds_dwordx4 v2, s[18:19] offset:-1024 nt
    s_add_u32 m0, s31, 57920
    s_waitcnt lgkmcnt(5)
    s_branch L_mid0
    .p2align 12
L_page0:
    s_branch L_back
    .p2align 6
L_loop0:
    v_mfma_f32_16x16x32_bf16 v[92:95], a[192:195], a[0:3], 0
    ds_read_b128 a[248:251], v1 offset:33376
    v_add_f32 v29, v29, v124
    v_mfma_f32_16x16x32_bf16 v[92:95], a[196:199], a[4:7], v[92:95]
    ds_read_b128 a[252:255], v1 offset:33392
    v_fma_f32 v125, v125, s29, -v34
    v_mfma_f32_16x16x32_bf16 v[92:95], a[200:203], a[8:11], v[92:95]
    v_mfma_f32_16x16x32_bf16 v[92:95], a[204:207], a[12:15], v[92:95]
    s_add_u32 m0, s31, 91184
    v_exp_f32 v125, v125
    v_mfma_f32_16x16x32_bf16 v[92:95], a[208:211], a[16:19], v[92:95]
    global_load_lds_dwordx4 v2, s[14:15] offset:-1024 nt
    s_mov_b32 m0, s25
    v_mfma_f32_16x16x32_bf16 v[92:95], a[212:215], a[20:23], v[92:95]
    ds_write_addtid_b32 v52 offset:0
    v_fma_f32 v126, v126, s29, -v34
    v_mfma_f32_16x16x32_bf16 v[92:95], a[216:219], a[24:27], v[92:95]
    ds_write_addtid_b32 v53 offset:256
    v_cvt_pk_bf16_f32 v66, v124, v125
    v_mfma_f32_16x16x32_bf16 v[92:95], a[220:223], a[28:31], v[92:95]
    v_exp_f32 v126, v126
    v_mfma_f32_16x16x32_bf16 v[96:99], a[192:195], a[32:35], 0
    ds_write_addtid_b32 v56 offset:1024
    v_add_f32 v29, v29, v125
    v_mfma_f32_16x16x32_bf16 v[96:99], a[196:199], a[36:39], v[96:99]
    v_fma_f32 v127, v127, s29, -v34
    v_mfma_f32_16x16x32_bf16 v[96:99], a[200:203], a[40:43], v[96:99]
    ds_write_addtid_b32 v57 offset:1280
    v_add_f32 v29, v29, v126
    v_mfma_f32_16x16x32_bf16 v[96:99], a[204:207], a[44:47], v[96:99]
    s_add_u32 m0, s31, 91200
    v_exp_f32 v127, v127
    v_mfma_f32_16x16x32_bf16 v[96:99], a[208:211], a[48:51], v[96:99]
    global_load_lds_dwordx4 v2, s[14:15] offset:0 nt
    s_mov_b32 m0, s25
    v_mfma_f32_16x16x32_bf16 v[96:99], a[212:215], a[52:55], v[96:99]
    ds_write_addtid_b32 v60 offset:2048
    v_fma_f32 v92, v92, s29, -v31
    v_mfma_f32_16x16x32_bf16 v[96:99], a[216:219], a[56:59], v[96:99]
    ds_write_addtid_b32 v61 offset:2304
    v_cvt_pk_bf16_f32 v67, v126, v127
    v_mfma_f32_16x16x32_bf16 v[96:99], a[220:223], a[60:63], v[96:99]
    v_exp_f32 v92, v92
    v_mfma_f32_16x16x32_bf16 v[100:103], a[192:195], a[64:67], 0
    ds_write_addtid_b32 v64 offset:3072
    v_add_f32 v26, v26, v92
    v_mfma_f32_16x16x32_bf16 v[100:103], a[196:199], a[68:71], v[100:103]
    ds_write_addtid_b32 v65 offset:3328
    v_fma_f32 v93, v93, s29, -v31
    v_mfma_f32_16x16x32_bf16 v[100:103], a[200:203], a[72:75], v[100:103]
    ds_write_addtid_b32 v68 offset:4096
    v_add_f32 v29, v29, v127
    v_mfma_f32_16x16x32_bf16 v[100:103], a[204:207], a[76:79], v[100:103]
    s_add_u32 m0, s31, 91216
    v_exp_f32 v93, v93
    v_mfma_f32_16x16x32_bf16 v[100:103], a[208:211], a[80:83], v[100:103]
    global_load_lds_dwordx4 v2, s[14:15] offset:1024 nt
    s_mov_b32 m0, s25
    v_mfma_f32_16x16x32_bf16 v[100:103], a[212:215], a[84:87], v[100:103]
    ds_write_addtid_b32 v69 offset:4352
    v_fma_f32 v94, v94, s29, -v31
    v_mfma_f32_16x16x32_bf16 v[100:103], a[216:219], a[88:91], v[100:103]
    ds_write_addtid_b32 v54 offset:512
    v_cvt_pk_bf16_f32 v72, v92, v93
    v_mfma_f32_16x16x32_bf16 v[100:103], a[220:223], a[92:95], v[100:103]
    v_exp_f32 v94, v94
    v_mfma_f32_16x16x32_bf16 v[104:107], a[192:195], a[96:99], 0
    ds_write_addtid_b32 v55 offset:768
    v_add_f32 v26, v26, v93
    v_mfma_f32_16x16x32_bf16 v[104:107], a[196:199], a[100:103], v[104:107]
    ds_write_addtid_b32 v58 offset:1536
    v_fma_f32 v95, v95, s29, -v31
    v_mfma_f32_16x16x32_bf16 v[104:107], a[200:203], a[104:107], v[104:107]
    ds_write_addtid_b32 v59 offset:1792
    v_add_f32 v26, v26, v94
    v_mfma_f32_16x16x32_bf16 v[104:107], a[204:207], a[108:111], v[104:107]
    s_add_u32 m0, s31, 91232
    v_exp_f32 v95, v95
    v_mfma_f32_16x16x32_bf16 v[104:107], a[208:211], a[112:115], v[104:107]
    global_load_lds_dwordx4 v2, s[14:15] offset:2048 nt
    s_mov_b32 m0, s25
    v_mfma_f32_16x16x32_bf16 v[104:107], a[212:215], a[116:119], v[104:107]
    ds_write_addtid_b32 v62 offset:2560
    v_fma_f32 v96, v96, s29, -v32
    v_mfma_f32_16x16x32_bf16 v[104:107], a[216:219], a[120:123], v[104:107]
    ds_write_addtid_b32 v63 offset:2816
    v_cvt_pk_bf16_f32 v73, v94, v95
    v_mfma_f32_16x16x32_bf16 v[104:107], a[220:223], a[124:127], v[104:107]
    v_exp_f32 v96, v96
    v_mfma_f32_16x16x32_bf16 v[108:111], a[192:195], a[128:131], 0
    ds_write_addtid_b32 v66 offset:3584
    v_add_f32 v26, v26, v95
    v_mfma_f32_16x16x32_bf16 v[108:111], a[196:199], a[132:135], v[108:111]
    v_fma_f32 v97, v97, s29, -v32
    v_mfma_f32_16x16x32_bf16 v[108:111], a[200:203], a[136:139], v[108:111]
    ds_write_addtid_b32 v67 offset:3840
    v_add_f32 v27, v27, v96
    v_mfma_f32_16x16x32_bf16 v[108:111], a[204:207], a[140:143], v[108:111]
    s_add_u32 m0, s31, 91248
    v_exp_f32 v97, v97
    v_mfma_f32_16x16x32_bf16 v[108:111], a[208:211], a[144:147], v[108:111]
    global_load_lds_dwordx4 v2, s[14:15] offset:3072 nt
    v_add_f32 v27, v27, v97
    v_mfma_f32_16x16x32_bf16 v[108:111], a[212:215], a[148:151], v[108:111]
    s_add_u32 s14, s14, 32768
    v_fma_f32 v98, v98, s29, -v32
    v_mfma_f32_16x16x32_bf16 v[108:111], a[216:219], a[152:155], v[108:111]
    s_addc_u32 s15, s15, 0
    v_cvt_pk_bf16_f32 v76, v96, v97
    v_mfma_f32_16x16x32_bf16 v[108:111], a[220:223], a[156:159], v[108:111]
    v_exp_f32 v98, v98
    v_mfma_f32_16x16x32_bf16 v[112:115], a[224:227], a[0:3], 0
    s_waitcnt lgkmcnt(1)
    v_add_f32 v27, v27, v98
    v_mfma_f32_16x16x32_bf16 v[112:115], a[228:231], a[4:7], v[112:115]
    s_waitcnt vmcnt(9) lgkmcnt(0)
    v_fma_f32 v99, v99, s29, -v32
    v_mfma_f32_16x16x32_bf16 v[112:115], a[232:235], a[8:11], v[112:115]
    s_barrier
    v_mfma_f32_16x16x32_bf16 v[112:115], a[236:239], a[12:15], v[112:115]
    s_add_u32 m0, s31, 57856
    v_exp_f32 v99, v99
    v_mfma_f32_16x16x32_bf16 v[112:115], a[240:243], a[16:19], v[112:115]
    global_load_lds_dwordx4 v2, s[18:19] offset:-4096 nt
    v_add_f32 v27, v27, v99
    v_mfma_f32_16x16x32_bf16 v[112:115], a[244:247], a[20:23], v[112:115]
    ds_read_b64_tr_b16 a[192:193], v4 offset:0
    v_fma_f32 v100, v100, s29, -v33
    v_mfma_f32_16x16x32_bf16 v[112:115], a[248:251], a[24:27], v[112:115]
    ds_read_b64_tr_b16 a[194:195], v6 offset:0
    v_cvt_pk_bf16_f32 v77, v98, v99
    v_mfma_f32_16x16x32_bf16 v[112:115], a[252:255], a[28:31], v[112:115]
    v_exp_f32 v100, v100
    v_mfma_f32_16x16x32_bf16 v[116:119], a[224:227], a[32:35], 0
    ds_read_b64_tr_b16 a[196:197], v8 offset:0
    v_add_f32 v28, v28, v100
    v_mfma_f32_16x16x32_bf16 v[116:119], a[228:231], a[36:39], v[116:119]
    s_add_u32 m0, s31, 57872
    ds_read_b64_tr_b16 a[198:199], v10 offset:0
    v_fma_f32 v101, v101, s29, -v33
    v_mfma_f32_16x16x32_bf16 v[116:119], a[232:235], a[40:43], v[116:119]
    global_load_lds_dwordx4 v2, s[18:19] offset:-3072 nt
    v_mfma_f32_16x16x32_bf16 v[116:119], a[236:239], a[44:47], v[116:119]
    v_exp_f32 v101, v101
    v_mfma_f32_16x16x32_bf16 v[116:119], a[240:243], a[48:51], v[116:119]
    ds_read2st64_b32 a[160:161], v13 offset0:0 offset1:1
    v_add_f32 v28, v28, v101
    v_mfma_f32_16x16x32_bf16 v[116:119], a[244:247], a[52:55], v[116:119]
    ds_read2st64_b32 a[162:163], v13 offset0:2 offset1:3
    v_fma_f32 v102, v102, s29, -v33
    v_mfma_f32_16x16x32_bf16 v[116:119], a[248:251], a[56:59], v[116:119]
    ds_read2st64_b32 a[164:165], v13 offset0:4 offset1:5
    v_cvt_pk_bf16_f32 v80, v100, v101
    v_mfma_f32_16x16x32_bf16 v[116:119], a[252:255], a[60:63], v[116:119]
    v_exp_f32 v102, v102
    v_mfma_f32_16x16x32_bf16 v[120:123], a[224:227], a[64:67], 0
    s_add_u32 m0, s31, 57888
    ds_read2st64_b32 a[166:167], v13 offset0:6 offset1:7
    v_add_f32 v28, v28, v102
    v_mfma_f32_16x16x32_bf16 v[120:123], a[228:231], a[68:71], v[120:123]
    global_load_lds_dwordx4 v2, s[18:19] offset:-2048 nt
    v_fma_f32 v103, v103, s29, -v33
    v_mfma_f32_16x16x32_bf16 v[120:123], a[232:235], a[72:75], v[120:123]
    ds_read2st64_b32 a[168:169], v13 offset0:8 offset1:9
    v_mfma_f32_16x16x32_bf16 v[120:123], a[236:239], a[76:79], v[120:123]
    v_exp_f32 v103, v103
    v_mfma_f32_16x16x32_bf16 v[120:123], a[240:243], a[80:83], v[120:123]
    ds_read2st64_b32 a[170:171], v13 offset0:10 offset1:11
    v_add_f32 v28, v28, v103
    v_mfma_f32_16x16x32_bf16 v[120:123], a[244:247], a[84:87], v[120:123]
    ds_read2st64_b32 a[172:173], v13 offset0:12 offset1:13
    v_fma_f32 v104, v104, s29, -v34
    v_mfma_f32_16x16x32_bf16 v[120:123], a[248:251], a[88:91], v[120:123]
    ds_read2st64_b32 a[174:175], v13 offset0:14 offset1:15
    v_cvt_pk_bf16_f32 v81, v102, v103
    v_mfma_f32_16x16x32_bf16 v[120:123], a[252:255], a[92:95], v[120:123]
    s_add_u32 m0, s31, 57904
    v_exp_f32 v104, v104
    v_mfma_f32_16x16x32_bf16 v[124:127], a[224:227], a[96:99], 0
    global_load_lds_dwordx4 v2, s[18:19] offset:-1024 nt
    v_add_f32 v29, v29, v104
    v_mfma_f32_16x16x32_bf16 v[124:127], a[228:231], a[100:103], v[124:127]
    ds_read2st64_b32 v[70:71], v14 offset0:16 offset1:17
    v_fma_f32 v105, v105, s29, -v34
    v_mfma_f32_16x16x32_bf16 v[124:127], a[232:235], a[104:107], v[124:127]
    ds_read2st64_b32 a[176:177], v13 offset0:16 offset1:17
    v_mfma_f32_16x16x32_bf16 v[124:127], a[236:239], a[108:111], v[124:127]
    v_exp_f32 v105, v105
    v_mfma_f32_16x16x32_bf16 v[124:127], a[240:243], a[112:115], v[124:127]
    ds_read2st64_b32 a[178:179], v15 offset0:16 offset1:17
    v_add_f32 v29, v29, v105
    v_mfma_f32_16x16x32_bf16 v[124:127], a[244:247], a[116:119], v[124:127]
    ds_read_b64_tr_b16 a[200:201], v4 offset:32
    v_fma_f32 v106, v106, s29, -v34
    v_mfma_f32_16x16x32_bf16 v[124:127], a[248:251], a[120:123], v[124:127]
    s_waitcnt lgkmcnt(4)
    ds_read_b64_tr_b16 a[202:203], v6 offset:32
    v_cvt_pk_bf16_f32 v84, v104, v105
    v_mfma_f32_16x16x32_bf16 v[124:127], a[252:255], a[124:127], v[124:127]
    s_add_u32 m0, s31, 57920
    v_exp_f32 v106, v106
L_mid0:
    v_mfma_f32_16x16x32_bf16 v[128:131], a[192:195], v[52:55], v[128:131]
    global_load_lds_dwordx4 v2, s[18:19] offset:0 nt
    v_add_f32 v29, v29, v106
    v_mfma_f32_16x16x32_bf16 v[128:131], a[196:199], a[160:163], v[128:131]
    ds_read_b64_tr_b16 a[204:205], v8 offset:32
    v_fma_f32 v107, v107, s29, -v34
    v_mfma_f32_16x16x32_bf16 v[160:163], a[196:199], a[164:167], v[160:163]
    ds_read_b64_tr_b16 a[206:207], v10 offset:32
    v_mfma_f32_16x16x32_bf16 v[160:163], a[192:195], v[56:59], v[160:163]
    v_exp_f32 v107, v107
    v_mfma_f32_16x16x32_bf16 v[192:195], a[192:195], v[60:63], v[192:195]
    ds_read_b64_tr_b16 a[208:209], v4 offset:64
    v_add_f32 v29, v29, v107
    v_mfma_f32_16x16x32_bf16 v[192:195], a[196:199], a[168:171], v[192:195]
    s_add_u32 m0, s31, 57936
    ds_read_b64_tr_b16 a[210:211], v6 offset:64
    v_fma_f32 v108, v108, s29, -v35
    v_mfma_f32_16x16x32_bf16 v[224:227], a[196:199], a[172:175], v[224:227]
    global_load_lds_dwordx4 v2, s[18:19] offset:1024 nt
    v_cvt_pk_bf16_f32 v85, v106, v107
    v_mfma_f32_16x16x32_bf16 v[224:227], a[192:195], v[64:67], v[224:227]
    s_waitcnt lgkmcnt(4)
    v_exp_f32 v108, v108
    v_mfma_f32_16x16x32_bf16 v[36:39], a[192:195], v[68:71], v[36:39]
    ds_read_b64_tr_b16 a[212:213], v8 offset:64
    v_add_f32 v30, v30, v108
    v_mfma_f32_16x16x32_bf16 v[36:39], a[196:199], a[176:179], v[36:39]
    ds_read_b64_tr_b16 a[214:215], v10 offset:64
    v_fma_f32 v109, v109, s29, -v35
    v_mfma_f32_16x16x32_bf16 v[132:135], a[200:203], v[52:55], v[132:135]
    s_waitcnt lgkmcnt(4)
    ds_read_b64_tr_b16 a[216:217], v4 offset:96
    v_mfma_f32_16x16x32_bf16 v[132:135], a[204:207], a[160:163], v[132:135]
    v_exp_f32 v109, v109
    v_mfma_f32_16x16x32_bf16 v[164:167], a[204:207], a[164:167], v[164:167]
    ds_read_b64_tr_b16 a[218:219], v6 offset:96
    v_add_f32 v30, v30, v109
    v_mfma_f32_16x16x32_bf16 v[164:167], a[200:203], v[56:59], v[164:167]
    s_add_u32 m0, s31, 57952
    ds_read_b64_tr_b16 a[220:221], v8 offset:96
    v_fma_f32 v110, v110, s29, -v35
    v_mfma_f32_16x16x32_bf16 v[196:199], a[200:203], v[60:63], v[196:199]
    global_load_lds_dwordx4 v2, s[18:19] offset:2048 nt
    v_cvt_pk_bf16_f32 v88, v108, v109
    v_mfma_f32_16x16x32_bf16 v[196:199], a[204:207], a[168:171], v[196:199]
    v_exp_f32 v110, v110
    v_mfma_f32_16x16x32_bf16 v[228:231], a[204:207], a[172:175], v[228:231]
    ds_read_b64_tr_b16 a[222:223], v10 offset:96
    v_add_f32 v30, v30, v110
    v_mfma_f32_16x16x32_bf16 v[228:231], a[200:203], v[64:67], v[228:231]
    ds_read_b64_tr_b16 a[224:225], v5 offset:0
    v_fma_f32 v111, v111, s29, -v35
    v_mfma_f32_16x16x32_bf16 v[40:43], a[200:203], v[68:71], v[40:43]
    ds_read_b64_tr_b16 a[226:227], v7 offset:0
    v_mfma_f32_16x16x32_bf16 v[40:43], a[204:207], a[176:179], v[40:43]
    s_waitcnt lgkmcnt(5)
    v_exp_f32 v111, v111
    v_mfma_f32_16x16x32_bf16 v[136:139], a[208:211], v[52:55], v[136:139]
    s_add_u32 m0, s31, 57968
    ds_read_b64_tr_b16 a[228:229], v9 offset:0
    v_add_f32 v30, v30, v111
    v_mfma_f32_16x16x32_bf16 v[136:139], a[212:215], a[160:163], v[136:139]
    global_load_lds_dwordx4 v2, s[18:19] offset:3072 nt
    v_fma_f32 v112, v112, s29, -v31
    v_mfma_f32_16x16x32_bf16 v[168:171], a[212:215], a[164:167], v[168:171]
    s_add_u32 s18, s18, 32768
    ds_read_b64_tr_b16 a[230:231], v11 offset:0
    v_cvt_pk_bf16_f32 v89, v110, v111
    v_mfma_f32_16x16x32_bf16 v[168:171], a[208:211], v[56:59], v[168:171]
    s_addc_u32 s19, s19, 0
    v_exp_f32 v112, v112
    v_mfma_f32_16x16x32_bf16 v[200:203], a[208:211], v[60:63], v[200:203]
    ds_read_b64_tr_b16 a[232:233], v5 offset:32
    v_add_f32 v26, v26, v112
    v_mfma_f32_16x16x32_bf16 v[200:203], a[212:215], a[168:171], v[200:203]
    ds_read_b64_tr_b16 a[234:235], v7 offset:32
    v_fma_f32 v113, v113, s29, -v31
    v_mfma_f32_16x16x32_bf16 v[232:235], a[212:215], a[172:175], v[232:235]
    ds_read_b64_tr_b16 a[236:237], v9 offset:32
    v_mfma_f32_16x16x32_bf16 v[232:235], a[208:211], v[64:67], v[232:235]
    s_add_u32 m0, s31, 124416
    v_exp_f32 v113, v113
    v_mfma_f32_16x16x32_bf16 v[44:47], a[208:211], v[68:71], v[44:47]
    global_load_lds_dwordx4 v2, s[14:15] offset:-4096 nt
    v_add_f32 v26, v26, v113
    v_mfma_f32_16x16x32_bf16 v[44:47], a[212:215], a[176:179], v[44:47]
    s_waitcnt lgkmcnt(4)
    ds_read_b64_tr_b16 a[238:239], v11 offset:32
    v_fma_f32 v114, v114, s29, -v31
    v_mfma_f32_16x16x32_bf16 v[140:143], a[216:219], v[52:55], v[140:143]
    ds_read_b64_tr_b16 a[240:241], v5 offset:64
    v_cvt_pk_bf16_f32 v74, v112, v113
    v_mfma_f32_16x16x32_bf16 v[140:143], a[220:223], a[160:163], v[140:143]
    v_exp_f32 v114, v114
    v_mfma_f32_16x16x32_bf16 v[172:175], a[220:223], a[164:167], v[172:175]
    ds_read_b64_tr_b16 a[242:243], v7 offset:64
    v_add_f32 v26, v26, v114
    v_mfma_f32_16x16x32_bf16 v[172:175], a[216:219], v[56:59], v[172:175]
    ds_read_b64_tr_b16 a[244:245], v9 offset:64
    v_fma_f32 v115, v115, s29, -v31
    v_mfma_f32_16x16x32_bf16 v[204:207], a[216:219], v[60:63], v[204:207]
    ds_read_b64_tr_b16 a[246:247], v11 offset:64
    v_mfma_f32_16x16x32_bf16 v[204:207], a[220:223], a[168:171], v[204:207]
    v_exp_f32 v115, v115
    v_mfma_f32_16x16x32_bf16 v[236:239], a[220:223], a[172:175], v[236:239]
    ds_read_b64_tr_b16 a[248:249], v5 offset:96
    v_add_f32 v26, v26, v115
    v_mfma_f32_16x16x32_bf16 v[236:239], a[216:219], v[64:67], v[236:239]
    ds_read_b64_tr_b16 a[250:251], v7 offset:96
    v_fma_f32 v116, v116, s29, -v32
    v_mfma_f32_16x16x32_bf16 v[48:51], a[216:219], v[68:71], v[48:51]
    ds_read_b64_tr_b16 a[252:253], v9 offset:96
    v_cvt_pk_bf16_f32 v75, v114, v115
    v_mfma_f32_16x16x32_bf16 v[48:51], a[220:223], a[176:179], v[48:51]
    v_exp_f32 v116, v116
    v_mfma_f32_16x16x32_bf16 v[144:147], a[224:227], v[52:55], v[144:147]
    s_waitcnt lgkmcnt(5)
    ds_read_b64_tr_b16 a[254:255], v11 offset:96
    v_add_f32 v27, v27, v116
    v_mfma_f32_16x16x32_bf16 v[144:147], a[228:231], a[160:163], v[144:147]
    v_fma_f32 v117, v117, s29, -v32
    v_mfma_f32_16x16x32_bf16 v[176:179], a[228:231], a[164:167], v[176:179]
    buffer_load_dword v25, v3, s[36:39], s35 offen
    v_mfma_f32_16x16x32_bf16 v[176:179], a[224:227], v[56:59], v[176:179]
    s_add_u32 s35, s35, 16384
    v_exp_f32 v117, v117
    v_mfma_f32_16x16x32_bf16 v[208:211], a[224:227], v[60:63], v[208:211]
    v_add_f32 v27, v27, v117
    v_mfma_f32_16x16x32_bf16 v[208:211], a[228:231], a[168:171], v[208:211]
    s_waitcnt vmcnt(10) lgkmcnt(0)
    v_fma_f32 v118, v118, s29, -v32
    v_mfma_f32_16x16x32_bf16 v[240:243], a[228:231], a[172:175], v[240:243]
    s_barrier
    v_cvt_pk_bf16_f32 v78, v116, v117
    v_mfma_f32_16x16x32_bf16 v[240:243], a[224:227], v[64:67], v[240:243]
    v_exp_f32 v118, v118
    v_mfma_f32_16x16x32_bf16 v[148:151], a[232:235], v[52:55], v[148:151]
    ds_read_b128 a[192:195], v0 offset:0
    v_add_f32 v27, v27, v118
    v_mfma_f32_16x16x32_bf16 v[148:151], a[236:239], a[160:163], v[148:151]
    v_fma_f32 v119, v119, s29, -v32
    v_mfma_f32_16x16x32_bf16 v[180:183], a[236:239], a[164:167], v[180:183]
    ds_read_b128 a[196:199], v0 offset:16
    v_mfma_f32_16x16x32_bf16 v[180:183], a[232:235], v[56:59], v[180:183]
    v_exp_f32 v119, v119
    v_mfma_f32_16x16x32_bf16 v[212:215], a[232:235], v[60:63], v[212:215]
    ds_read_b128 a[200:203], v0 offset:32
    v_add_f32 v27, v27, v119
    v_mfma_f32_16x16x32_bf16 v[212:215], a[236:239], a[168:171], v[212:215]
    ds_read_b128 a[204:207], v0 offset:48
    v_fma_f32 v120, v120, s29, -v33
    v_mfma_f32_16x16x32_bf16 v[244:247], a[236:239], a[172:175], v[244:247]
    ds_read_b128 a[208:211], v0 offset:64
    v_cvt_pk_bf16_f32 v79, v118, v119
    v_mfma_f32_16x16x32_bf16 v[244:247], a[232:235], v[64:67], v[244:247]
    v_exp_f32 v120, v120
    v_mfma_f32_16x16x32_bf16 v[152:155], a[240:243], v[52:55], v[152:155]
    v_add_f32 v28, v28, v120
    v_mfma_f32_16x16x32_bf16 v[152:155], a[244:247], a[160:163], v[152:155]
    ds_read_b128 a[212:215], v0 offset:80
    v_fma_f32 v121, v121, s29, -v33
    v_mfma_f32_16x16x32_bf16 v[184:187], a[244:247], a[164:167], v[184:187]
    ds_read_b128 a[216:219], v0 offset:96
    v_mfma_f32_16x16x32_bf16 v[184:187], a[240:243], v[56:59], v[184:187]
    s_add_u32 m0, s31, 124432
    v_exp_f32 v121, v121
    v_mfma_f32_16x16x32_bf16 v[216:219], a[240:243], v[60:63], v[216:219]
    global_load_lds_dwordx4 v2, s[14:15] offset:-3072 nt
    v_add_f32 v28, v28, v121
    v_mfma_f32_16x16x32_bf16 v[216:219], a[244:247], a[168:171], v[216:219]
    ds_read_b128 a[220:223], v0 offset:112
    v_fma_f32 v122, v122, s29, -v33
    v_mfma_f32_16x16x32_bf16 v[248:251], a[244:247], a[172:175], v[248:251]
    ds_read_b128 a[224:227], v1 offset:0
    v_cvt_pk_bf16_f32 v82, v120, v121
    v_mfma_f32_16x16x32_bf16 v[248:251], a[240:243], v[64:67], v[248:251]
    v_exp_f32 v122, v122
    v_mfma_f32_16x16x32_bf16 v[156:159], a[248:251], v[52:55], v[156:159]
    ds_read_b128 a[228:231], v1 offset:16
    v_add_f32 v28, v28, v122
    v_mfma_f32_16x16x32_bf16 v[156:159], a[252:255], a[160:163], v[156:159]
    ds_read_b128 a[232:235], v1 offset:32
    v_fma_f32 v123, v123, s29, -v33
    v_mfma_f32_16x16x32_bf16 v[188:191], a[252:255], a[164:167], v[188:191]
    ds_read_b128 a[236:239], v1 offset:48
    v_mfma_f32_16x16x32_bf16 v[188:191], a[248:251], v[56:59], v[188:191]
    s_add_u32 m0, s31, 124448
    v_exp_f32 v123, v123
    v_mfma_f32_16x16x32_bf16 v[220:223], a[248:251], v[60:63], v[220:223]
    global_load_lds_dwordx4 v2, s[14:15] offset:-2048 nt
    v_add_f32 v28, v28, v123
    v_mfma_f32_16x16x32_bf16 v[220:223], a[252:255], a[168:171], v[220:223]
    ds_read_b128 a[240:243], v1 offset:64
    v_fma_f32 v124, v124, s29, -v34
    v_mfma_f32_16x16x32_bf16 v[252:255], a[252:255], a[172:175], v[252:255]
    s_waitcnt lgkmcnt(4)
    ds_read_b128 a[244:247], v1 offset:80
    v_cvt_pk_bf16_f32 v83, v122, v123
    v_mfma_f32_16x16x32_bf16 v[252:255], a[248:251], v[64:67], v[252:255]
    v_exp_f32 v124, v124
    v_mfma_f32_16x16x32_bf16 v[92:95], a[192:195], a[0:3], 0
    ds_read_b128 a[248:251], v1 offset:96
    v_add_f32 v29, v29, v124
    v_mfma_f32_16x16x32_bf16 v[92:95], a[196:199], a[4:7], v[92:95]
    ds_read_b128 a[252:255], v1 offset:112
    v_fma_f32 v125, v125, s29, -v34
    v_mfma_f32_16x16x32_bf16 v[92:95], a[200:203], a[8:11], v[92:95]
    v_mfma_f32_16x16x32_bf16 v[92:95], a[204:207], a[12:15], v[92:95]
    s_add_u32 m0, s31, 124464
    v_exp_f32 v125, v125
    v_mfma_f32_16x16x32_bf16 v[92:95], a[208:211], a[16:19], v[92:95]
    global_load_lds_dwordx4 v2, s[14:15] offset:-1024 nt
    s_mov_b32 m0, s25
    v_mfma_f32_16x16x32_bf16 v[92:95], a[212:215], a[20:23], v[92:95]
    ds_write_addtid_b32 v72 offset:0
    v_fma_f32 v126, v126, s29, -v34
    v_mfma_f32_16x16x32_bf16 v[92:95], a[216:219], a[24:27], v[92:95]
    ds_write_addtid_b32 v73 offset:256
    v_cvt_pk_bf16_f32 v86, v124, v125
    v_mfma_f32_16x16x32_bf16 v[92:95], a[220:223], a[28:31], v[92:95]
    v_exp_f32 v126, v126
    v_mfma_f32_16x16x32_bf16 v[96:99], a[192:195], a[32:35], 0
    ds_write_addtid_b32 v76 offset:1024
    v_add_f32 v29, v29, v125
    v_mfma_f32_16x16x32_bf16 v[96:99], a[196:199], a[36:39], v[96:99]
    v_fma_f32 v127, v127, s29, -v34
    v_mfma_f32_16x16x32_bf16 v[96:99], a[200:203], a[40:43], v[96:99]
    ds_write_addtid_b32 v77 offset:1280
    v_add_f32 v29, v29, v126
    v_mfma_f32_16x16x32_bf16 v[96:99], a[204:207], a[44:47], v[96:99]
    s_add_u32 m0, s31, 124480
    v_exp_f32 v127, v127
    v_mfma_f32_16x16x32_bf16 v[96:99], a[208:211], a[48:51], v[96:99]
    global_load_lds_dwordx4 v2, s[14:15] offset:0 nt
    s_mov_b32 m0, s25
    v_mfma_f32_16x16x32_bf16 v[96:99], a[212:215], a[52:55], v[96:99]
    ds_write_addtid_b32 v80 offset:2048
    v_fma_f32 v92, v92, s29, -v31
    v_mfma_f32_16x16x32_bf16 v[96:99], a[216:219], a[56:59], v[96:99]
    ds_write_addtid_b32 v81 offset:2304
    v_cvt_pk_bf16_f32 v87, v126, v127
    v_mfma_f32_16x16x32_bf16 v[96:99], a[220:223], a[60:63], v[96:99]
    v_exp_f32 v92, v92
    v_mfma_f32_16x16x32_bf16 v[100:103], a[192:195], a[64:67], 0
    ds_write_addtid_b32 v84 offset:3072
    v_add_f32 v26, v26, v92
    v_mfma_f32_16x16x32_bf16 v[100:103], a[196:199], a[68:71], v[100:103]
    ds_write_addtid_b32 v85 offset:3328
    v_fma_f32 v93, v93, s29, -v31
    v_mfma_f32_16x16x32_bf16 v[100:103], a[200:203], a[72:75], v[100:103]
    ds_write_addtid_b32 v88 offset:4096
    v_add_f32 v29, v29, v127
    v_mfma_f32_16x16x32_bf16 v[100:103], a[204:207], a[76:79], v[100:103]
    s_add_u32 m0, s31, 124496
    v_exp_f32 v93, v93
    v_mfma_f32_16x16x32_bf16 v[100:103], a[208:211], a[80:83], v[100:103]
    global_load_lds_dwordx4 v2, s[14:15] offset:1024 nt
    s_mov_b32 m0, s25
    v_mfma_f32_16x16x32_bf16 v[100:103], a[212:215], a[84:87], v[100:103]
    ds_write_addtid_b32 v89 offset:4352
    v_fma_f32 v94, v94, s29, -v31
    v_mfma_f32_16x16x32_bf16 v[100:103], a[216:219], a[88:91], v[100:103]
    ds_write_addtid_b32 v74 offset:512
    v_cvt_pk_bf16_f32 v52, v92, v93
    v_mfma_f32_16x16x32_bf16 v[100:103], a[220:223], a[92:95], v[100:103]
    v_exp_f32 v94, v94
    v_mfma_f32_16x16x32_bf16 v[104:107], a[192:195], a[96:99], 0
    ds_write_addtid_b32 v75 offset:768
    v_add_f32 v26, v26, v93
    v_mfma_f32_16x16x32_bf16 v[104:107], a[196:199], a[100:103], v[104:107]
    ds_write_addtid_b32 v78 offset:1536
    v_fma_f32 v95, v95, s29, -v31
    v_mfma_f32_16x16x32_bf16 v[104:107], a[200:203], a[104:107], v[104:107]
    ds_write_addtid_b32 v79 offset:1792
    v_add_f32 v26, v26, v94
    v_mfma_f32_16x16x32_bf16 v[104:107], a[204:207], a[108:111], v[104:107]
    s_add_u32 m0, s31, 124512
    v_exp_f32 v95, v95
    v_mfma_f32_16x16x32_bf16 v[104:107], a[208:211], a[112:115], v[104:107]
    global_load_lds_dwordx4 v2, s[14:15] offset:2048 nt
    s_mov_b32 m0, s25
    v_mfma_f32_16x16x32_bf16 v[104:107], a[212:215], a[116:119], v[104:107]
    ds_write_addtid_b32 v82 offset:2560
    v_fma_f32 v96, v96, s29, -v32
    v_mfma_f32_16x16x32_bf16 v[104:107], a[216:219], a[120:123], v[104:107]
    ds_write_addtid_b32 v83 offset:2816
    v_cvt_pk_bf16_f32 v53, v94, v95
    v_mfma_f32_16x16x32_bf16 v[104:107], a[220:223], a[124:127], v[104:107]
    v_exp_f32 v96, v96
    v_mfma_f32_16x16x32_bf16 v[108:111], a[192:195], a[128:131], 0
    ds_write_addtid_b32 v86 offset:3584
    v_add_f32 v26, v26, v95
    v_mfma_f32_16x16x32_bf16 v[108:111], a[196:199], a[132:135], v[108:111]
    v_fma_f32 v97, v97, s29, -v32
    v_mfma_f32_16x16x32_bf16 v[108:111], a[200:203], a[136:139], v[108:111]
    ds_write_addtid_b32 v87 offset:3840
    v_add_f32 v27, v27, v96
    v_mfma_f32_16x16x32_bf16 v[108:111], a[204:207], a[140:143], v[108:111]
    s_add_u32 m0, s31, 124528
    v_exp_f32 v97, v97
    v_mfma_f32_16x16x32_bf16 v[108:111], a[208:211], a[144:147], v[108:111]
    s_waitcnt lgkmcnt(4)
    global_load_lds_dwordx4 v2, s[14:15] offset:3072 nt
    v_add_f32 v27, v27, v97
    v_mfma_f32_16x16x32_bf16 v[108:111], a[212:215], a[148:151], v[108:111]
    s_add_u32 s14, s14, 32768
    v_fma_f32 v98, v98, s29, -v32
    v_mfma_f32_16x16x32_bf16 v[108:111], a[216:219], a[152:155], v[108:111]
    s_addc_u32 s15, s15, 0
    v_cvt_pk_bf16_f32 v56, v96, v97
    v_mfma_f32_16x16x32_bf16 v[108:111], a[220:223], a[156:159], v[108:111]
    s_cmp_eq_u32 s14, s26
    v_exp_f32 v98, v98
    v_mfma_f32_16x16x32_bf16 v[112:115], a[224:227], a[0:3], 0
    s_cselect_b64 s[14:15], s[52:53], s[14:15]
    v_add_f32 v27, v27, v98
    v_mfma_f32_16x16x32_bf16 v[112:115], a[228:231], a[4:7], v[112:115]
    s_waitcnt vmcnt(9) lgkmcnt(0)
    v_fma_f32 v99, v99, s29, -v32
    v_mfma_f32_16x16x32_bf16 v[112:115], a[232:235], a[8:11], v[112:115]
    s_barrier
    v_mfma_f32_16x16x32_bf16 v[112:115], a[236:239], a[12:15], v[112:115]
    s_add_u32 m0, s31, 24576
    v_exp_f32 v99, v99
    v_mfma_f32_16x16x32_bf16 v[112:115], a[240:243], a[16:19], v[112:115]
    global_load_lds_dwordx4 v2, s[18:19] offset:-4096 nt
    v_add_f32 v27, v27, v99
    v_mfma_f32_16x16x32_bf16 v[112:115], a[244:247], a[20:23], v[112:115]
    ds_read_b64_tr_b16 a[192:193], v4 offset:33280
    v_fma_f32 v100, v100, s29, -v33
    v_mfma_f32_16x16x32_bf16 v[112:115], a[248:251], a[24:27], v[112:115]
    ds_read_b64_tr_b16 a[194:195], v6 offset:33280
    v_cvt_pk_bf16_f32 v57, v98, v99
    v_mfma_f32_16x16x32_bf16 v[112:115], a[252:255], a[28:31], v[112:115]
    v_exp_f32 v100, v100
    v_mfma_f32_16x16x32_bf16 v[116:119], a[224:227], a[32:35], 0
    ds_read_b64_tr_b16 a[196:197], v8 offset:33280
    v_add_f32 v28, v28, v100
    v_mfma_f32_16x16x32_bf16 v[116:119], a[228:231], a[36:39], v[116:119]
    s_add_u32 m0, s31, 24592
    ds_read_b64_tr_b16 a[198:199], v10 offset:33280
    v_fma_f32 v101, v101, s29, -v33
    v_mfma_f32_16x16x32_bf16 v[116:119], a[232:235], a[40:43], v[116:119]
    global_load_lds_dwordx4 v2, s[18:19] offset:-3072 nt
    v_mfma_f32_16x16x32_bf16 v[116:119], a[236:239], a[44:47], v[116:119]
    v_exp_f32 v101, v101
    v_mfma_f32_16x16x32_bf16 v[116:119], a[240:243], a[48:51], v[116:119]
    ds_read2st64_b32 a[160:161], v13 offset0:0 offset1:1
    v_add_f32 v28, v28, v101
    v_mfma_f32_16x16x32_bf16 v[116:119], a[244:247], a[52:55], v[116:119]
    ds_read2st64_b32 a[162:163], v13 offset0:2 offset1:3
    v_fma_f32 v102, v102, s29, -v33
    v_mfma_f32_16x16x32_bf16 v[116:119], a[248:251], a[56:59], v[116:119]
    ds_read2st64_b32 a[164:165], v13 offset0:4 offset1:5
    v_cvt_pk_bf16_f32 v60, v100, v101
    v_mfma_f32_16x16x32_bf16 v[116:119], a[252:255], a[60:63], v[116:119]
    v_exp_f32 v102, v102
    v_mfma_f32_16x16x32_bf16 v[120:123], a[224:227], a[64:67], 0
    s_add_u32 m0, s31, 24608
    ds_read2st64_b32 a[166:167], v13 offset0:6 offset1:7
    v_add_f32 v28, v28, v102
    v_mfma_f32_16x16x32_bf16 v[120:123], a[228:231], a[68:71], v[120:123]
    global_load_lds_dwordx4 v2, s[18:19] offset:-2048 nt
    v_fma_f32 v103, v103, s29, -v33
    v_mfma_f32_16x16x32_bf16 v[120:123], a[232:235], a[72:75], v[120:123]
    ds_read2st64_b32 a[168:169], v13 offset0:8 offset1:9
    v_mfma_f32_16x16x32_bf16 v[120:123], a[236:239], a[76:79], v[120:123]
    v_exp_f32 v103, v103
    v_mfma_f32_16x16x32_bf16 v[120:123], a[240:243], a[80:83], v[120:123]
L_page1:
    s_cbranch_scc1 L_back
    ds_read2st64_b32 a[170:171], v13 offset0:10 offset1:11
    v_add_f32 v28, v28, v103
    v_mfma_f32_16x16x32_bf16 v[120:123], a[244:247], a[84:87], v[120:123]
    ds_read2st64_b32 a[172:173], v13 offset0:12 offset1:13
    v_fma_f32 v104, v104, s29, -v34
    v_mfma_f32_16x16x32_bf16 v[120:123], a[248:251], a[88:91], v[120:123]
    ds_read2st64_b32 a[174:175], v13 offset0:14 offset1:15
    v_cvt_pk_bf16_f32 v61, v102, v103
    v_mfma_f32_16x16x32_bf16 v[120:123], a[252:255], a[92:95], v[120:123]
    s_add_u32 m0, s31, 24624
    v_exp_f32 v104, v104
    v_mfma_f32_16x16x32_bf16 v[124:127], a[224:227], a[96:99], 0
    global_load_lds_dwordx4 v2, s[18:19] offset:-1024 nt
    v_add_f32 v29, v29, v104
    v_mfma_f32_16x16x32_bf16 v[124:127], a[228:231], a[100:103], v[124:127]
    ds_read2st64_b32 v[90:91], v14 offset0:16 offset1:17
    v_fma_f32 v105, v105, s29, -v34
    v_mfma_f32_16x16x32_bf16 v[124:127], a[232:235], a[104:107], v[124:127]
    ds_read2st64_b32 a[176:177], v13 offset0:16 offset1:17
    v_mfma_f32_16x16x32_bf16 v[124:127], a[236:239], a[108:111], v[124:127]
    v_exp_f32 v105, v105
    v_mfma_f32_16x16x32_bf16 v[124:127], a[240:243], a[112:115], v[124:127]
    ds_read2st64_b32 a[178:179], v15 offset0:16 offset1:17
    v_add_f32 v29, v29, v105
    v_mfma_f32_16x16x32_bf16 v[124:127], a[244:247], a[116:119], v[124:127]
    ds_read_b64_tr_b16 a[200:201], v4 offset:33312
    v_fma_f32 v106, v106, s29, -v34
    v_mfma_f32_16x16x32_bf16 v[124:127], a[248:251], a[120:123], v[124:127]
    s_waitcnt lgkmcnt(4)
    ds_read_b64_tr_b16 a[202:203], v6 offset:33312
    v_cvt_pk_bf16_f32 v64, v104, v105
    v_mfma_f32_16x16x32_bf16 v[124:127], a[252:255], a[124:127], v[124:127]
    s_add_u32 m0, s31, 24640
    v_exp_f32 v106, v106
    v_mfma_f32_16x16x32_bf16 v[128:131], a[192:195], v[72:75], v[128:131]
    global_load_lds_dwordx4 v2, s[18:19] offset:0 nt
    v_add_f32 v29, v29, v106
    v_mfma_f32_16x16x32_bf16 v[128:131], a[196:199], a[160:163], v[128:131]
    ds_read_b64_tr_b16 a[204:205], v8 offset:33312
    v_fma_f32 v107, v107, s29, -v34
    v_mfma_f32_16x16x32_bf16 v[160:163], a[196:199], a[164:167], v[160:163]
    ds_read_b64_tr_b16 a[206:207], v10 offset:33312
    v_mfma_f32_16x16x32_bf16 v[160:163], a[192:195], v[76:79], v[160:163]
    v_exp_f32 v107, v107
    v_mfma_f32_16x16x32_bf16 v[192:195], a[192:195], v[80:83], v[192:195]
    ds_read_b64_tr_b16 a[208:209], v4 offset:33344
    v_add_f32 v29, v29, v107
    v_mfma_f32_16x16x32_bf16 v[192:195], a[196:199], a[168:171], v[192:195]
    s_add_u32 m0, s31, 24656
    ds_read_b64_tr_b16 a[210:211], v6 offset:33344
    v_fma_f32 v108, v108, s29, -v35
    v_mfma_f32_16x16x32_bf16 v[224:227], a[196:199], a[172:175], v[224:227]
    global_load_lds_dwordx4 v2, s[18:19] offset:1024 nt
    v_cvt_pk_bf16_f32 v65, v106, v107
    v_mfma_f32_16x16x32_bf16 v[224:227], a[192:195], v[84:87], v[224:227]
    s_waitcnt lgkmcnt(4)
    v_exp_f32 v108, v108
    v_mfma_f32_16x16x32_bf16 v[36:39], a[192:195], v[88:91], v[36:39]
    ds_read_b64_tr_b16 a[212:213], v8 offset:33344
    v_add_f32 v30, v30, v108
    v_mfma_f32_16x16x32_bf16 v[36:39], a[196:199], a[176:179], v[36:39]
    ds_read_b64_tr_b16 a[214:215], v10 offset:33344
    v_fma_f32 v109, v109, s29, -v35
    v_mfma_f32_16x16x32_bf16 v[132:135], a[200:203], v[72:75], v[132:135]
    s_waitcnt lgkmcnt(4)
    ds_read_b64_tr_b16 a[216:217], v4 offset:33376
    v_mfma_f32_16x16x32_bf16 v[132:135], a[204:207], a[160:163], v[132:135]
    v_exp_f32 v109, v109
    v_mfma_f32_16x16x32_bf16 v[164:167], a[204:207], a[164:167], v[164:167]
    ds_read_b64_tr_b16 a[218:219], v6 offset:33376
    v_add_f32 v30, v30, v109
    v_mfma_f32_16x16x32_bf16 v[164:167], a[200:203], v[76:79], v[164:167]
    s_add_u32 m0, s31, 24672
    ds_read_b64_tr_b16 a[220:221], v8 offset:33376
    v_fma_f32 v110, v110, s29, -v35
    v_mfma_f32_16x16x32_bf16 v[196:199], a[200:203], v[80:83], v[196:199]
    global_load_lds_dwordx4 v2, s[18:19] offset:2048 nt
    v_cvt_pk_bf16_f32 v68, v108, v109
    v_mfma_f32_16x16x32_bf16 v[196:199], a[204:207], a[168:171], v[196:199]
    v_exp_f32 v110, v110
    v_mfma_f32_16x16x32_bf16 v[228:231], a[204:207], a[172:175], v[228:231]
    ds_read_b64_tr_b16 a[222:223], v10 offset:33376
    v_add_f32 v30, v30, v110
    v_mfma_f32_16x16x32_bf16 v[228:231], a[200:203], v[84:87], v[228:231]
    ds_read_b64_tr_b16 a[224:225], v5 offset:33280
    v_fma_f32 v111, v111, s29, -v35
    v_mfma_f32_16x16x32_bf16 v[40:43], a[200:203], v[88:91], v[40:43]
    ds_read_b64_tr_b16 a[226:227], v7 offset:33280
    v_mfma_f32_16x16x32_bf16 v[40:43], a[204:207], a[176:179], v[40:43]
    s_waitcnt lgkmcnt(5)
    v_exp_f32 v111, v111
    v_mfma_f32_16x16x32_bf16 v[136:139], a[208:211], v[72:75], v[136:139]
    s_add_u32 m0, s31, 24688
    ds_read_b64_tr_b16 a[228:229], v9 offset:33280
    v_add_f32 v30, v30, v111
    v_mfma_f32_16x16x32_bf16 v[136:139], a[212:215], a[160:163], v[136:139]
    global_load_lds_dwordx4 v2, s[18:19] offset:3072 nt
    v_fma_f32 v112, v112, s29, -v31
    v_mfma_f32_16x16x32_bf16 v[168:171], a[212:215], a[164:167], v[168:171]
    s_add_u32 s18, s18, 32768
    ds_read_b64_tr_b16 a[230:231], v11 offset:33280
    v_cvt_pk_bf16_f32 v69, v110, v111
    v_mfma_f32_16x16x32_bf16 v[168:171], a[208:211], v[76:79], v[168:171]
    s_addc_u32 s19, s19, 0
    v_exp_f32 v112, v112
    v_mfma_f32_16x16x32_bf16 v[200:203], a[208:211], v[80:83], v[200:203]
    ds_read_b64_tr_b16 a[232:233], v5 offset:33312
    v_add_f32 v26, v26, v112
    v_mfma_f32_16x16x32_bf16 v[200:203], a[212:215], a[168:171], v[200:203]
    ds_read_b64_tr_b16 a[234:235], v7 offset:33312
    v_fma_f32 v113, v113, s29, -v31
    v_mfma_f32_16x16x32_bf16 v[232:235], a[212:215], a[172:175], v[232:235]
    ds_read_b64_tr_b16 a[236:237], v9 offset:33312
    v_mfma_f32_16x16x32_bf16 v[232:235], a[208:211], v[84:87], v[232:235]
    s_add_u32 m0, s31, 91136
    v_exp_f32 v113, v113
    v_mfma_f32_16x16x32_bf16 v[44:47], a[208:211], v[88:91], v[44:47]
    global_load_lds_dwordx4 v2, s[14:15] offset:-4096 nt
    v_add_f32 v26, v26, v113
    v_mfma_f32_16x16x32_bf16 v[44:47], a[212:215], a[176:179], v[44:47]
    s_waitcnt lgkmcnt(4)
    ds_read_b64_tr_b16 a[238:239], v11 offset:33312
    v_fma_f32 v114, v114, s29, -v31
    v_mfma_f32_16x16x32_bf16 v[140:143], a[216:219], v[72:75], v[140:143]
    ds_read_b64_tr_b16 a[240:241], v5 offset:33344
    v_cvt_pk_bf16_f32 v54, v112, v113
    v_mfma_f32_16x16x32_bf16 v[140:143], a[220:223], a[160:163], v[140:143]
    v_exp_f32 v114, v114
    v_mfma_f32_16x16x32_bf16 v[172:175], a[220:223], a[164:167], v[172:175]
    ds_read_b64_tr_b16 a[242:243], v7 offset:33344
    v_add_f32 v26, v26, v114
    v_mfma_f32_16x16x32_bf16 v[172:175], a[216:219], v[76:79], v[172:175]
    ds_read_b64_tr_b16 a[244:245], v9 offset:33344
    v_fma_f32 v115, v115, s29, -v31
    v_mfma_f32_16x16x32_bf16 v[204:207], a[216:219], v[80:83], v[204:207]
    ds_read_b64_tr_b16 a[246:247], v11 offset:33344
    v_mfma_f32_16x16x32_bf16 v[204:207], a[220:223], a[168:171], v[204:207]
    v_exp_f32 v115, v115
    v_mfma_f32_16x16x32_bf16 v[236:239], a[220:223], a[172:175], v[236:239]
    ds_read_b64_tr_b16 a[248:249], v5 offset:33376
    v_add_f32 v26, v26, v115
    v_mfma_f32_16x16x32_bf16 v[236:239], a[216:219], v[84:87], v[236:239]
    ds_read_b64_tr_b16 a[250:251], v7 offset:33376
    v_fma_f32 v116, v116, s29, -v32
    v_mfma_f32_16x16x32_bf16 v[48:51], a[216:219], v[88:91], v[48:51]
    ds_read_b64_tr_b16 a[252:253], v9 offset:33376
    v_cvt_pk_bf16_f32 v55, v114, v115
    v_mfma_f32_16x16x32_bf16 v[48:51], a[220:223], a[176:179], v[48:51]
    v_exp_f32 v116, v116
    v_mfma_f32_16x16x32_bf16 v[144:147], a[224:227], v[72:75], v[144:147]
    s_waitcnt lgkmcnt(5)
    ds_read_b64_tr_b16 a[254:255], v11 offset:33376
    v_add_f32 v27, v27, v116
    v_mfma_f32_16x16x32_bf16 v[144:147], a[228:231], a[160:163], v[144:147]
    v_fma_f32 v117, v117, s29, -v32
    v_mfma_f32_16x16x32_bf16 v[176:179], a[228:231], a[164:167], v[176:179]
    buffer_load_dword v25, v3, s[36:39], s35 offen
    v_mfma_f32_16x16x32_bf16 v[176:179], a[224:227], v[76:79], v[176:179]
    s_add_u32 s35, s35, 16384
    v_exp_f32 v117, v117
    v_mfma_f32_16x16x32_bf16 v[208:211], a[224:227], v[80:83], v[208:211]
    s_cmp_eq_u32 s35, 32768
    v_add_f32 v27, v27, v117
    v_mfma_f32_16x16x32_bf16 v[208:211], a[228:231], a[168:171], v[208:211]
    s_cselect_b64 s[36:37], s[4:5], s[36:37]
    s_waitcnt vmcnt(10) lgkmcnt(0)
    v_fma_f32 v118, v118, s29, -v32
    v_mfma_f32_16x16x32_bf16 v[240:243], a[228:231], a[172:175], v[240:243]
    s_barrier
    v_cvt_pk_bf16_f32 v58, v116, v117
    v_mfma_f32_16x16x32_bf16 v[240:243], a[224:227], v[84:87], v[240:243]
    v_exp_f32 v118, v118
    v_mfma_f32_16x16x32_bf16 v[148:151], a[232:235], v[72:75], v[148:151]
    ds_read_b128 a[192:195], v0 offset:33280
    v_add_f32 v27, v27, v118
    v_mfma_f32_16x16x32_bf16 v[148:151], a[236:239], a[160:163], v[148:151]
    v_fma_f32 v119, v119, s29, -v32
    v_mfma_f32_16x16x32_bf16 v[180:183], a[236:239], a[164:167], v[180:183]
    ds_read_b128 a[196:199], v0 offset:33296
    v_mfma_f32_16x16x32_bf16 v[180:183], a[232:235], v[76:79], v[180:183]
    v_exp_f32 v119, v119
    v_mfma_f32_16x16x32_bf16 v[212:215], a[232:235], v[80:83], v[212:215]
    ds_read_b128 a[200:203], v0 offset:33312
    v_add_f32 v27, v27, v119
    v_mfma_f32_16x16x32_bf16 v[212:215], a[236:239], a[168:171], v[212:215]
    ds_read_b128 a[204:207], v0 offset:33328
    v_fma_f32 v120, v120, s29, -v33
    v_mfma_f32_16x16x32_bf16 v[244:247], a[236:239], a[172:175], v[244:247]
    ds_read_b128 a[208:211], v0 offset:33344
    v_cvt_pk_bf16_f32 v59, v118, v119
    v_mfma_f32_16x16x32_bf16 v[244:247], a[232:235], v[84:87], v[244:247]
    v_exp_f32 v120, v120
    v_mfma_f32_16x16x32_bf16 v[152:155], a[240:243], v[72:75], v[152:155]
    v_add_f32 v28, v28, v120
    v_mfma_f32_16x16x32_bf16 v[152:155], a[244:247], a[160:163], v[152:155]
    ds_read_b128 a[212:215], v0 offset:33360
    v_fma_f32 v121, v121, s29, -v33
    v_mfma_f32_16x16x32_bf16 v[184:187], a[244:247], a[164:167], v[184:187]
    ds_read_b128 a[216:219], v0 offset:33376
    v_mfma_f32_16x16x32_bf16 v[184:187], a[240:243], v[76:79], v[184:187]
    s_add_u32 m0, s31, 91152
    v_exp_f32 v121, v121
    v_mfma_f32_16x16x32_bf16 v[216:219], a[240:243], v[80:83], v[216:219]
    global_load_lds_dwordx4 v2, s[14:15] offset:-3072 nt
    v_add_f32 v28, v28, v121
    v_mfma_f32_16x16x32_bf16 v[216:219], a[244:247], a[168:171], v[216:219]
    ds_read_b128 a[220:223], v0 offset:33392
    v_fma_f32 v122, v122, s29, -v33
    v_mfma_f32_16x16x32_bf16 v[248:251], a[244:247], a[172:175], v[248:251]
    ds_read_b128 a[224:227], v1 offset:33280
    v_cvt_pk_bf16_f32 v62, v120, v121
    v_mfma_f32_16x16x32_bf16 v[248:251], a[240:243], v[84:87], v[248:251]
    v_exp_f32 v122, v122
    v_mfma_f32_16x16x32_bf16 v[156:159], a[248:251], v[72:75], v[156:159]
    ds_read_b128 a[228:231], v1 offset:33296
    v_add_f32 v28, v28, v122
    v_mfma_f32_16x16x32_bf16 v[156:159], a[252:255], a[160:163], v[156:159]
    ds_read_b128 a[232:235], v1 offset:33312
    v_fma_f32 v123, v123, s29, -v33
    v_mfma_f32_16x16x32_bf16 v[188:191], a[252:255], a[164:167], v[188:191]
    ds_read_b128 a[236:239], v1 offset:33328
    v_mfma_f32_16x16x32_bf16 v[188:191], a[248:251], v[76:79], v[188:191]
    s_add_u32 m0, s31, 91168
    v_exp_f32 v123, v123
    v_mfma_f32_16x16x32_bf16 v[220:223], a[248:251], v[80:83], v[220:223]
    global_load_lds_dwordx4 v2, s[14:15] offset:-2048 nt
    v_add_f32 v28, v28, v123
    v_mfma_f32_16x16x32_bf16 v[220:223], a[252:255], a[168:171], v[220:223]
    ds_read_b128 a[240:243], v1 offset:33344
    v_fma_f32 v124, v124, s29, -v34
    v_mfma_f32_16x16x32_bf16 v[252:255], a[252:255], a[172:175], v[252:255]
    s_waitcnt lgkmcnt(4)
    ds_read_b128 a[244:247], v1 offset:33360
    v_cvt_pk_bf16_f32 v63, v122, v123
    v_mfma_f32_16x16x32_bf16 v[252:255], a[248:251], v[84:87], v[252:255]
    s_sub_u32 s28, s28, 1
    v_exp_f32 v124, v124
    s_cbranch_scc0 L_loop0
L_tail:
    s_add_u32 m0, s31, 91184
    ds_read_b128 a[248:251], v1 offset:33376
    global_load_lds_dwordx4 v2, s[14:15] offset:-1024 nt
    s_add_u32 m0, s31, 91200
    ds_read_b128 a[252:255], v1 offset:33392
    v_add_u32 v12, s25, v2
    v_mfma_f32_16x16x32_bf16 v[92:95], a[192:195], a[0:3], 0
    ds_write_b64 v12, v[68:69] offset:4096
    v_mfma_f32_16x16x32_bf16 v[92:95], a[196:199], a[4:7], v[92:95]
    v_add_f32 v29, v29, v124
    v_fma_f32 v125, v125, s29, -v34
    v_mfma_f32_16x16x32_bf16 v[92:95], a[200:203], a[8:11], v[92:95]
    v_exp_f32 v125, v125
    v_mfma_f32_16x16x32_bf16 v[92:95], a[204:207], a[12:15], v[92:95]
    ds_write_b128 v12, v[52:55] offset:0
    global_load_lds_dwordx4 v2, s[14:15] offset:0 nt
    s_add_u32 m0, s31, 91216
    v_mfma_f32_16x16x32_bf16 v[92:95], a[208:211], a[16:19], v[92:95]
    v_fma_f32 v126, v126, s29, -v34
    v_cvt_pk_bf16_f32 v66, v124, v125
    v_mfma_f32_16x16x32_bf16 v[92:95], a[212:215], a[20:23], v[92:95]
    v_exp_f32 v126, v126
    v_mfma_f32_16x16x32_bf16 v[92:95], a[216:219], a[24:27], v[92:95]
    v_add_f32 v29, v29, v125
    v_fma_f32 v127, v127, s29, -v34
    v_mfma_f32_16x16x32_bf16 v[92:95], a[220:223], a[28:31], v[92:95]
    v_add_f32 v29, v29, v126
    v_add_u32 v13, s57, v2
    v_mfma_f32_16x16x32_bf16 v[108:111], a[192:195], a[128:131], 0
    ds_write_b128 v12, v[56:59] offset:1024
    global_load_lds_dwordx4 v2, s[14:15] offset:1024 nt
    s_add_u32 m0, s31, 91232
    v_mfma_f32_16x16x32_bf16 v[108:111], a[196:199], a[132:135], v[108:111]
    v_exp_f32 v127, v127
    v_mfma_f32_16x16x32_bf16 v[108:111], a[200:203], a[136:139], v[108:111]
    v_cvt_pk_bf16_f32 v67, v126, v127
    v_add_f32 v29, v29, v127
    v_mfma_f32_16x16x32_bf16 v[108:111], a[204:207], a[140:143], v[108:111]
    v_add_u32 v14, s58, v2
    v_add_u32 v15, s59, v2
    v_mfma_f32_16x16x32_bf16 v[108:111], a[208:211], a[144:147], v[108:111]
    v_mov_b32 v24, 1.0
    v_fma_f32 v92, v92, s29, -v31
    v_mfma_f32_16x16x32_bf16 v[108:111], a[212:215], a[148:151], v[108:111]
    ds_write_b128 v12, v[60:63] offset:2048
    global_load_lds_dwordx4 v2, s[14:15] offset:2048 nt
    s_add_u32 m0, s31, 91248
    v_mfma_f32_16x16x32_bf16 v[108:111], a[216:219], a[152:155], v[108:111]
    v_fma_f32 v93, v93, s29, -v31
    v_fma_f32 v94, v94, s29, -v31
    v_mfma_f32_16x16x32_bf16 v[108:111], a[220:223], a[156:159], v[108:111]
    v_fma_f32 v95, v95, s29, -v31
    v_xor_b32 v3, 4096, v21
    v_mfma_f32_16x16x32_bf16 v[112:115], a[224:227], a[0:3], 0
    s_waitcnt lgkmcnt(4)
    v_exp_f32 v92, v92
    v_mfma_f32_16x16x32_bf16 v[112:115], a[228:231], a[4:7], v[112:115]
    v_exp_f32 v93, v93
    v_mfma_f32_16x16x32_bf16 v[112:115], a[232:235], a[8:11], v[112:115]
    ds_write_b128 v12, v[64:67] offset:3072
    global_load_lds_dwordx4 v2, s[14:15] offset:3072 nt
    v_mfma_f32_16x16x32_bf16 v[112:115], a[236:239], a[12:15], v[112:115]
    v_xor_b32 v2, 2048, v21
    v_add_f32 v26, v26, v92
    v_mfma_f32_16x16x32_bf16 v[112:115], a[240:243], a[16:19], v[112:115]
    v_exp_f32 v94, v94
    v_mfma_f32_16x16x32_bf16 v[112:115], a[244:247], a[20:23], v[112:115]
    v_exp_f32 v95, v95
    v_mfma_f32_16x16x32_bf16 v[112:115], a[248:251], a[24:27], v[112:115]
    v_add_f32 v26, v26, v93
    v_cvt_pk_bf16_f32 v72, v92, v93
    v_mfma_f32_16x16x32_bf16 v[112:115], a[252:255], a[28:31], v[112:115]
    v_add_f32 v26, v26, v94
    v_add_f32 v26, v26, v95
    v_mfma_f32_16x16x32_bf16 v[96:99], a[192:195], a[32:35], 0
    v_cvt_pk_bf16_f32 v73, v94, v95
    v_fma_f32 v108, v108, s29, -v35
    v_mfma_f32_16x16x32_bf16 v[96:99], a[196:199], a[36:39], v[96:99]
    v_fma_f32 v109, v109, s29, -v35
    v_fma_f32 v110, v110, s29, -v35
    v_mfma_f32_16x16x32_bf16 v[96:99], a[200:203], a[40:43], v[96:99]
    v_fma_f32 v112, v112, s29, -v31
    v_fma_f32 v113, v113, s29, -v31
    v_mfma_f32_16x16x32_bf16 v[96:99], a[204:207], a[44:47], v[96:99]
    v_fma_f32 v114, v114, s29, -v31
    v_fma_f32 v115, v115, s29, -v31
    v_mfma_f32_16x16x32_bf16 v[96:99], a[208:211], a[48:51], v[96:99]
    v_exp_f32 v112, v112
    v_mfma_f32_16x16x32_bf16 v[96:99], a[212:215], a[52:55], v[96:99]
    s_waitcnt vmcnt(9) lgkmcnt(0)
    s_barrier
    v_exp_f32 v113, v113
    v_mfma_f32_16x16x32_bf16 v[96:99], a[216:219], a[56:59], v[96:99]
    v_exp_f32 v114, v114
    v_mfma_f32_16x16x32_bf16 v[96:99], a[220:223], a[60:63], v[96:99]
    v_exp_f32 v115, v115
    v_mfma_f32_16x16x32_bf16 v[116:119], a[224:227], a[32:35], 0
    v_add_f32 v26, v26, v112
    v_add_f32 v26, v26, v113
    v_mfma_f32_16x16x32_bf16 v[116:119], a[228:231], a[36:39], v[116:119]
    v_cvt_pk_bf16_f32 v74, v112, v113
    v_add_f32 v26, v26, v114
    v_mfma_f32_16x16x32_bf16 v[116:119], a[232:235], a[40:43], v[116:119]
    v_add_f32 v26, v26, v115
    v_cvt_pk_bf16_f32 v75, v114, v115
    v_mfma_f32_16x16x32_bf16 v[116:119], a[236:239], a[44:47], v[116:119]
    ds_write_b128 v12, v[72:75] offset:53760
    v_mfma_f32_16x16x32_bf16 v[116:119], a[240:243], a[48:51], v[116:119]
    v_fma_f32 v96, v96, s29, -v32
    v_fma_f32 v97, v97, s29, -v32
    v_mfma_f32_16x16x32_bf16 v[116:119], a[244:247], a[52:55], v[116:119]
    v_fma_f32 v98, v98, s29, -v32
    v_fma_f32 v99, v99, s29, -v32
    v_mfma_f32_16x16x32_bf16 v[116:119], a[248:251], a[56:59], v[116:119]
    v_exp_f32 v96, v96
    v_mfma_f32_16x16x32_bf16 v[116:119], a[252:255], a[60:63], v[116:119]
    v_exp_f32 v97, v97
    v_mfma_f32_16x16x32_bf16 v[100:103], a[192:195], a[64:67], 0
    ds_write_b32 v21, v26 offset:0
    v_mfma_f32_16x16x32_bf16 v[100:103], a[196:199], a[68:71], v[100:103]
    v_exp_f32 v98, v98
    v_mfma_f32_16x16x32_bf16 v[100:103], a[200:203], a[72:75], v[100:103]
    ds_read_b128 a[160:163], v13 offset:0
    v_add_f32 v27, v27, v96
    v_mfma_f32_16x16x32_bf16 v[100:103], a[204:207], a[76:79], v[100:103]
    ds_read_b128 a[164:167], v13 offset:1024
    v_add_f32 v27, v27, v97
    v_mfma_f32_16x16x32_bf16 v[100:103], a[208:211], a[80:83], v[100:103]
    ds_read_b128 a[168:171], v13 offset:2048
    v_cvt_pk_bf16_f32 v76, v96, v97
    v_mfma_f32_16x16x32_bf16 v[100:103], a[212:215], a[84:87], v[100:103]
    ds_read_b128 a[172:175], v13 offset:3072
    v_add_f32 v27, v27, v98
    v_mfma_f32_16x16x32_bf16 v[100:103], a[216:219], a[88:91], v[100:103]
    ds_read_b64 v[70:71], v14 offset:4096
    v_fma_f32 v116, v116, s29, -v32
    v_mfma_f32_16x16x32_bf16 v[100:103], a[220:223], a[92:95], v[100:103]
    ds_read_b64 a[176:177], v13 offset:4096
    v_fma_f32 v117, v117, s29, -v32
    v_mfma_f32_16x16x32_bf16 v[120:123], a[224:227], a[64:67], 0
    ds_read_b64 a[178:179], v15 offset:4096
    v_fma_f32 v118, v118, s29, -v32
    v_mfma_f32_16x16x32_bf16 v[120:123], a[228:231], a[68:71], v[120:123]
    ds_read_b64_tr_b16 a[128:129], v4 offset:0
    v_fma_f32 v119, v119, s29, -v32
    v_mfma_f32_16x16x32_bf16 v[120:123], a[232:235], a[72:75], v[120:123]
    ds_read_b64_tr_b16 a[130:131], v6 offset:0
    v_fma_f32 v111, v111, s29, -v35
    v_mfma_f32_16x16x32_bf16 v[120:123], a[236:239], a[76:79], v[120:123]
    ds_read_b64_tr_b16 a[132:133], v8 offset:0
    v_fma_f32 v100, v100, s29, -v33
    v_mfma_f32_16x16x32_bf16 v[120:123], a[240:243], a[80:83], v[120:123]
    ds_read_b64_tr_b16 a[134:135], v10 offset:0
    v_fma_f32 v101, v101, s29, -v33
    v_mfma_f32_16x16x32_bf16 v[120:123], a[244:247], a[84:87], v[120:123]
    ds_read_b64_tr_b16 a[136:137], v4 offset:32
    v_fma_f32 v102, v102, s29, -v33
    v_mfma_f32_16x16x32_bf16 v[120:123], a[248:251], a[88:91], v[120:123]
    ds_read_b64_tr_b16 a[138:139], v6 offset:32
    v_fma_f32 v103, v103, s29, -v33
    v_mfma_f32_16x16x32_bf16 v[120:123], a[252:255], a[92:95], v[120:123]
    s_waitcnt lgkmcnt(4)
    ds_read_b64_tr_b16 a[140:141], v8 offset:32
    v_xor_b32 v23, 6144, v21
    v_mfma_f32_16x16x32_bf16 v[128:131], a[128:131], v[52:55], v[128:131]
    ds_read_b64_tr_b16 a[142:143], v10 offset:32
    ds_read_b64_tr_b16 a[144:145], v4 offset:64
    ds_read_b64_tr_b16 a[146:147], v6 offset:64
    ds_read_b64_tr_b16 a[148:149], v8 offset:64
    ds_read_b64_tr_b16 a[150:151], v10 offset:64
    v_fma_f32 v120, v120, s29, -v33
    s_waitcnt lgkmcnt(8)
    v_mfma_f32_16x16x32_bf16 v[128:131], a[132:135], a[160:163], v[128:131]
    ds_read_b64_tr_b16 a[152:153], v4 offset:96
    ds_read_b64_tr_b16 a[154:155], v6 offset:96
    ds_read_b64_tr_b16 a[156:157], v8 offset:96
    ds_read_b64_tr_b16 a[158:159], v10 offset:96
    ds_read_b64_tr_b16 a[0:1], v5 offset:0
    v_add_u32 v4, 0x10400, v4
    s_waitcnt lgkmcnt(11)
    v_mfma_f32_16x16x32_bf16 v[132:135], a[136:139], v[52:55], v[132:135]
    ds_read_b64_tr_b16 a[2:3], v7 offset:0
    ds_read_b64_tr_b16 a[4:5], v9 offset:0
    ds_read_b64_tr_b16 a[6:7], v11 offset:0
    ds_read_b64_tr_b16 a[8:9], v5 offset:32
    ds_read_b64_tr_b16 a[10:11], v7 offset:32
    v_add_u32 v6, 0x10400, v6
    s_waitcnt lgkmcnt(14)
    v_mfma_f32_16x16x32_bf16 v[132:135], a[140:143], a[160:163], v[132:135]
    s_waitcnt vmcnt(0)
    s_barrier
    ds_read_b64_tr_b16 a[12:13], v9 offset:32
    v_add_u32 v8, 0x10400, v8
    s_waitcnt lgkmcnt(13)
    v_mfma_f32_16x16x32_bf16 v[136:139], a[144:147], v[52:55], v[136:139]
    s_waitcnt lgkmcnt(11)
    ds_read_b64_tr_b16 a[14:15], v11 offset:32
    v_add_u32 v10, 0x10400, v10
    v_mfma_f32_16x16x32_bf16 v[136:139], a[148:151], a[160:163], v[136:139]
    s_waitcnt lgkmcnt(10)
    ds_read_b64_tr_b16 a[16:17], v5 offset:64
    v_fma_f32 v121, v121, s29, -v33
    v_mfma_f32_16x16x32_bf16 v[140:143], a[152:155], v[52:55], v[140:143]
    s_waitcnt lgkmcnt(9)
    ds_read_b64_tr_b16 a[18:19], v7 offset:64
    v_fma_f32 v122, v122, s29, -v33
    v_mfma_f32_16x16x32_bf16 v[140:143], a[156:159], a[160:163], v[140:143]
    s_waitcnt lgkmcnt(8)
    ds_read_b64_tr_b16 a[20:21], v9 offset:64
    v_fma_f32 v123, v123, s29, -v33
    v_mfma_f32_16x16x32_bf16 v[144:147], a[0:3], v[52:55], v[144:147]
    s_waitcnt lgkmcnt(7)
    ds_read_b64_tr_b16 a[22:23], v11 offset:64
    v_mfma_f32_16x16x32_bf16 v[144:147], a[4:7], a[160:163], v[144:147]
    s_waitcnt lgkmcnt(6)
    ds_read_b64_tr_b16 a[24:25], v5 offset:96
    v_add_u32 v5, 0x10400, v5
    v_mfma_f32_16x16x32_bf16 v[148:151], a[8:11], v[52:55], v[148:151]
    s_waitcnt lgkmcnt(5)
    ds_read_b64_tr_b16 a[26:27], v7 offset:96
    v_add_u32 v7, 0x10400, v7
    v_mfma_f32_16x16x32_bf16 v[148:151], a[12:15], a[160:163], v[148:151]
    s_waitcnt lgkmcnt(4)
    ds_read_b64_tr_b16 a[28:29], v9 offset:96
    v_add_u32 v9, 0x10400, v9
    v_mfma_f32_16x16x32_bf16 v[152:155], a[16:19], v[52:55], v[152:155]
    ds_read_b64_tr_b16 a[30:31], v11 offset:96
    v_add_u32 v11, 0x10400, v11
    v_mfma_f32_16x16x32_bf16 v[160:163], a[128:131], v[56:59], v[160:163]
    s_waitcnt lgkmcnt(4)
    ds_read_b128 a[180:183], v13 offset:53760
    v_mfma_f32_16x16x32_bf16 v[152:155], a[20:23], a[160:163], v[152:155]
    ds_read_b32 v113, v2 offset:0
    ds_read_b64_tr_b16 a[32:33], v4 offset:0
    ds_read_b64_tr_b16 a[34:35], v6 offset:0
    ds_read_b64_tr_b16 a[36:37], v8 offset:0
    ds_read_b64_tr_b16 a[38:39], v10 offset:0
    s_waitcnt lgkmcnt(8)
    v_mfma_f32_16x16x32_bf16 v[156:159], a[24:27], v[52:55], v[156:159]
    ds_read_b64_tr_b16 a[40:41], v4 offset:32
    ds_read_b64_tr_b16 a[42:43], v6 offset:32
    ds_read_b64_tr_b16 a[44:45], v8 offset:32
    ds_read_b64_tr_b16 a[46:47], v10 offset:32
    ds_read_b64_tr_b16 a[48:49], v4 offset:64
    s_waitcnt lgkmcnt(11)
    v_mfma_f32_16x16x32_bf16 v[156:159], a[28:31], a[160:163], v[156:159]
    ds_read_b64_tr_b16 a[50:51], v6 offset:64
    ds_read_b64_tr_b16 a[52:53], v8 offset:64
    ds_read_b64_tr_b16 a[54:55], v10 offset:64
    ds_read_b64_tr_b16 a[56:57], v4 offset:96
    ds_read_b64_tr_b16 a[58:59], v6 offset:96
    ds_read_b64_tr_b16 a[60:61], v8 offset:96
    s_waitcnt lgkmcnt(15)
    v_add_f32 v26, v26, v113
    v_mfma_f32_16x16x32_bf16 v[160:163], a[132:135], a[164:167], v[160:163]
    ds_read_b64_tr_b16 a[62:63], v10 offset:96
    v_mfma_f32_16x16x4_f32 v[112:115], v24, v26, 0
    ds_read_b64_tr_b16 a[64:65], v5 offset:0
    ds_read_b64_tr_b16 a[66:67], v7 offset:0
    ds_read_b64_tr_b16 a[68:69], v9 offset:0
    ds_read_b64_tr_b16 a[70:71], v11 offset:0
    ds_read_b64_tr_b16 a[72:73], v5 offset:32
    s_waitcnt lgkmcnt(15)
    v_mfma_f32_16x16x32_bf16 v[128:131], a[32:35], v[72:75], v[128:131]
    ds_read_b64_tr_b16 a[74:75], v7 offset:32
    v_mfma_f32_16x16x32_bf16 v[128:131], a[36:39], a[180:183], v[128:131]
    ds_read_b64_tr_b16 a[76:77], v9 offset:32
    v_mfma_f32_16x16x32_bf16 v[132:135], a[40:43], v[72:75], v[132:135]
    s_waitcnt lgkmcnt(14)
    v_rcp_f32 v112, v112
    v_mfma_f32_16x16x32_bf16 v[132:135], a[44:47], a[180:183], v[132:135]
    s_waitcnt lgkmcnt(12)
    ds_read_b64_tr_b16 a[78:79], v11 offset:32
    v_mfma_f32_16x16x32_bf16 v[136:139], a[48:51], v[72:75], v[136:139]
    s_waitcnt lgkmcnt(10)
    ds_read_b64_tr_b16 a[80:81], v5 offset:64
    v_mfma_f32_16x16x32_bf16 v[136:139], a[52:55], a[180:183], v[136:139]
    ds_read_b64_tr_b16 a[82:83], v7 offset:64
    v_mfma_f32_16x16x32_bf16 v[140:143], a[56:59], v[72:75], v[140:143]
    s_waitcnt lgkmcnt(10)
    ds_read_b64_tr_b16 a[84:85], v9 offset:64
    v_mfma_f32_16x16x32_bf16 v[140:143], a[60:63], a[180:183], v[140:143]
    s_waitcnt lgkmcnt(9)
    ds_read_b64_tr_b16 a[86:87], v11 offset:64
    v_mfma_f32_16x16x32_bf16 v[144:147], a[64:67], v[72:75], v[144:147]
    s_waitcnt lgkmcnt(7)
    ds_read_b64_tr_b16 a[88:89], v5 offset:96
    v_mfma_f32_16x16x32_bf16 v[144:147], a[68:71], a[180:183], v[144:147]
    ds_read_b64_tr_b16 a[90:91], v7 offset:96
    ds_read_b64_tr_b16 a[92:93], v9 offset:96
    ds_read_b64_tr_b16 a[94:95], v11 offset:96
    v_exp_f32 v99, v99
    v_pk_mul_f32 v[128:129], v[128:129], v[112:113] op_sel_hi:[1,0]
    v_pk_mul_f32 v[130:131], v[130:131], v[112:113] op_sel_hi:[1,0]
    v_pk_mul_f32 v[132:133], v[132:133], v[112:113] op_sel_hi:[1,0]
    v_pk_mul_f32 v[134:135], v[134:135], v[112:113] op_sel_hi:[1,0]
    v_pk_mul_f32 v[136:137], v[136:137], v[112:113] op_sel_hi:[1,0]
    v_pk_mul_f32 v[138:139], v[138:139], v[112:113] op_sel_hi:[1,0]
    v_pk_mul_f32 v[140:141], v[140:141], v[112:113] op_sel_hi:[1,0]
    v_pk_mul_f32 v[142:143], v[142:143], v[112:113] op_sel_hi:[1,0]
    s_waitcnt lgkmcnt(8)
    v_mfma_f32_16x16x32_bf16 v[148:151], a[72:75], v[72:75], v[148:151]
    v_cvt_pk_bf16_f32 v128, v128, v129
    v_cvt_pk_bf16_f32 v129, v130, v131
    v_mfma_f32_16x16x32_bf16 v[148:151], a[76:79], a[180:183], v[148:151]
    s_waitcnt lgkmcnt(5)
    v_cvt_pk_bf16_f32 v130, v132, v133
    v_cvt_pk_bf16_f32 v131, v134, v135
    v_mfma_f32_16x16x32_bf16 v[152:155], a[80:83], v[72:75], v[152:155]
    s_waitcnt lgkmcnt(4)
    v_permlane16_swap_b32 v128, v130
    v_mfma_f32_16x16x32_bf16 v[152:155], a[84:87], a[180:183], v[152:155]
    s_waitcnt lgkmcnt(2)
    v_permlane16_swap_b32 v129, v131
    v_mfma_f32_16x16x32_bf16 v[156:159], a[88:91], v[72:75], v[156:159]
    s_waitcnt lgkmcnt(0)
    v_cvt_pk_bf16_f32 v136, v136, v137
    v_cvt_pk_bf16_f32 v137, v138, v139
    v_mfma_f32_16x16x32_bf16 v[156:159], a[92:95], a[180:183], v[156:159]
    buffer_store_dwordx4 v[128:131], v22, s[20:23], s94 offen offset:0 sc0 sc1 nt
    v_cvt_pk_bf16_f32 v138, v140, v141
    v_cvt_pk_bf16_f32 v139, v142, v143
    v_mfma_f32_16x16x32_bf16 v[164:167], a[136:139], v[56:59], v[164:167]
    v_permlane16_swap_b32 v136, v138
    v_permlane16_swap_b32 v137, v139
    buffer_store_dwordx4 v[136:139], v22, s[20:23], s94 offen offset:64 sc0 sc1 nt
    v_mfma_f32_16x16x32_bf16 v[164:167], a[140:143], a[164:167], v[164:167]
    v_add_f32 v27, v27, v99
    v_cvt_pk_bf16_f32 v77, v98, v99
    v_exp_f32 v116, v116
    v_pk_mul_f32 v[144:145], v[144:145], v[112:113] op_sel_hi:[1,0]
    v_pk_mul_f32 v[146:147], v[146:147], v[112:113] op_sel_hi:[1,0]
    v_pk_mul_f32 v[148:149], v[148:149], v[112:113] op_sel_hi:[1,0]
    v_pk_mul_f32 v[150:151], v[150:151], v[112:113] op_sel_hi:[1,0]
    v_pk_mul_f32 v[152:153], v[152:153], v[112:113] op_sel_hi:[1,0]
    v_pk_mul_f32 v[154:155], v[154:155], v[112:113] op_sel_hi:[1,0]
    v_pk_mul_f32 v[156:157], v[156:157], v[112:113] op_sel_hi:[1,0]
    v_pk_mul_f32 v[158:159], v[158:159], v[112:113] op_sel_hi:[1,0]
    v_cvt_pk_bf16_f32 v144, v144, v145
    v_cvt_pk_bf16_f32 v145, v146, v147
    v_cvt_pk_bf16_f32 v146, v148, v149
    v_cvt_pk_bf16_f32 v147, v150, v151
    v_cvt_pk_bf16_f32 v152, v152, v153
L_page2:
    s_cbranch_scc1 L_back
    v_permlane16_swap_b32 v144, v146
    v_permlane16_swap_b32 v145, v147
    v_cvt_pk_bf16_f32 v153, v154, v155
    v_cvt_pk_bf16_f32 v154, v156, v157
    v_cvt_pk_bf16_f32 v155, v158, v159
    v_mfma_f32_16x16x32_bf16 v[168:171], a[144:147], v[56:59], v[168:171]
    v_permlane16_swap_b32 v152, v154
    v_permlane16_swap_b32 v153, v155
    v_mfma_f32_16x16x32_bf16 v[168:171], a[148:151], a[164:167], v[168:171]
    v_exp_f32 v117, v117
    v_mfma_f32_16x16x32_bf16 v[172:175], a[152:155], v[56:59], v[172:175]
    v_exp_f32 v118, v118
    v_mfma_f32_16x16x32_bf16 v[172:175], a[156:159], a[164:167], v[172:175]
    v_exp_f32 v119, v119
    v_mfma_f32_16x16x32_bf16 v[176:179], a[0:3], v[56:59], v[176:179]
    buffer_store_dwordx4 v[144:147], v22, s[20:23], s95 offen offset:0 sc0 sc1 nt
    v_mfma_f32_16x16x32_bf16 v[176:179], a[4:7], a[164:167], v[176:179]
    v_add_f32 v27, v27, v116
    v_add_f32 v27, v27, v117
    v_mfma_f32_16x16x32_bf16 v[180:183], a[8:11], v[56:59], v[180:183]
    v_cvt_pk_bf16_f32 v78, v116, v117
    v_add_f32 v27, v27, v118
    v_mfma_f32_16x16x32_bf16 v[180:183], a[12:15], a[164:167], v[180:183]
    v_add_f32 v27, v27, v119
    v_cvt_pk_bf16_f32 v79, v118, v119
    v_mfma_f32_16x16x32_bf16 v[184:187], a[16:19], v[56:59], v[184:187]
    ds_write_b128 v12, v[76:79] offset:54784
    v_mfma_f32_16x16x32_bf16 v[184:187], a[20:23], a[164:167], v[184:187]
    v_exp_f32 v108, v108
    v_mfma_f32_16x16x32_bf16 v[188:191], a[24:27], v[56:59], v[188:191]
    v_exp_f32 v109, v109
    v_mfma_f32_16x16x32_bf16 v[188:191], a[28:31], a[164:167], v[188:191]
    ds_write_b32 v21, v27 offset:4
    v_mfma_f32_16x16x32_bf16 v[160:163], a[32:35], v[76:79], v[160:163]
    v_exp_f32 v110, v110
    v_mfma_f32_16x16x32_bf16 v[164:167], a[40:43], v[76:79], v[164:167]
    v_exp_f32 v111, v111
    v_mfma_f32_16x16x32_bf16 v[168:171], a[48:51], v[76:79], v[168:171]
    v_add_f32 v30, v30, v108
    v_add_f32 v30, v30, v109
    v_mfma_f32_16x16x32_bf16 v[172:175], a[56:59], v[76:79], v[172:175]
    v_cvt_pk_bf16_f32 v88, v108, v109
    v_add_f32 v30, v30, v110
    v_mfma_f32_16x16x32_bf16 v[176:179], a[64:67], v[76:79], v[176:179]
    v_add_f32 v30, v30, v111
    v_cvt_pk_bf16_f32 v89, v110, v111
    v_mfma_f32_16x16x32_bf16 v[180:183], a[72:75], v[76:79], v[180:183]
    ds_write_b32 v21, v30 offset:1024
    v_mfma_f32_16x16x32_bf16 v[184:187], a[80:83], v[76:79], v[184:187]
    buffer_store_dwordx4 v[152:155], v22, s[20:23], s95 offen offset:64 sc0 sc1 nt
    v_mfma_f32_16x16x32_bf16 v[188:191], a[88:91], v[76:79], v[188:191]
    s_waitcnt lgkmcnt(1)
    s_barrier
    ds_read_b128 a[184:187], v13 offset:54784
    ds_read_b32 v117, v2 offset:4
    v_mfma_f32_16x16x32_bf16 v[192:195], a[128:131], v[60:63], v[192:195]
    ds_write_b64 v12, v[88:89] offset:57856
    v_mfma_f32_16x16x32_bf16 v[192:195], a[132:135], a[168:171], v[192:195]
    v_exp_f32 v100, v100
    v_mfma_f32_16x16x32_bf16 v[196:199], a[136:139], v[60:63], v[196:199]
    v_exp_f32 v101, v101
    v_mfma_f32_16x16x32_bf16 v[196:199], a[140:143], a[168:171], v[196:199]
    v_exp_f32 v102, v102
    v_mfma_f32_16x16x32_bf16 v[200:203], a[144:147], v[60:63], v[200:203]
    s_waitcnt lgkmcnt(2)
    v_exp_f32 v103, v103
    v_mfma_f32_16x16x32_bf16 v[160:163], a[36:39], a[184:187], v[160:163]
    s_waitcnt lgkmcnt(1)
    v_add_f32 v27, v27, v117
    v_add_f32 v28, v28, v100
    v_add_f32 v28, v28, v101
    v_mfma_f32_16x16x4_f32 v[116:119], v24, v27, 0
    v_cvt_pk_bf16_f32 v80, v100, v101
    v_add_f32 v28, v28, v102
    v_add_f32 v28, v28, v103
    v_cvt_pk_bf16_f32 v81, v102, v103
    v_exp_f32 v120, v120
    v_mfma_f32_16x16x32_bf16 v[164:167], a[44:47], a[184:187], v[164:167]
    v_exp_f32 v121, v121
    v_mfma_f32_16x16x32_bf16 v[168:171], a[52:55], a[184:187], v[168:171]
    v_exp_f32 v122, v122
    v_mfma_f32_16x16x32_bf16 v[172:175], a[60:63], a[184:187], v[172:175]
    v_rcp_f32 v116, v116
    v_mfma_f32_16x16x32_bf16 v[176:179], a[68:71], a[184:187], v[176:179]
    v_exp_f32 v123, v123
    v_mfma_f32_16x16x32_bf16 v[180:183], a[76:79], a[184:187], v[180:183]
    v_add_f32 v28, v28, v120
    v_add_f32 v28, v28, v121
    v_cvt_pk_bf16_f32 v82, v120, v121
    v_add_f32 v28, v28, v122
    v_add_f32 v28, v28, v123
    v_pk_mul_f32 v[160:161], v[160:161], v[116:117] op_sel_hi:[1,0]
    v_pk_mul_f32 v[162:163], v[162:163], v[116:117] op_sel_hi:[1,0]
    v_pk_mul_f32 v[164:165], v[164:165], v[116:117] op_sel_hi:[1,0]
    v_pk_mul_f32 v[166:167], v[166:167], v[116:117] op_sel_hi:[1,0]
    v_pk_mul_f32 v[168:169], v[168:169], v[116:117] op_sel_hi:[1,0]
    v_pk_mul_f32 v[170:171], v[170:171], v[116:117] op_sel_hi:[1,0]
    v_pk_mul_f32 v[172:173], v[172:173], v[116:117] op_sel_hi:[1,0]
    v_pk_mul_f32 v[174:175], v[174:175], v[116:117] op_sel_hi:[1,0]
    v_mfma_f32_16x16x32_bf16 v[184:187], a[84:87], a[184:187], v[184:187]
    v_cvt_pk_bf16_f32 v160, v160, v161
    v_cvt_pk_bf16_f32 v161, v162, v163
    v_mfma_f32_16x16x32_bf16 v[188:191], a[92:95], a[184:187], v[188:191]
    v_cvt_pk_bf16_f32 v162, v164, v165
    v_cvt_pk_bf16_f32 v163, v166, v167
    v_cvt_pk_bf16_f32 v168, v168, v169
    v_permlane16_swap_b32 v160, v162
    v_permlane16_swap_b32 v161, v163
    buffer_store_dwordx4 v[160:163], v22, s[20:23], s96 offen offset:0 sc0 sc1 nt
    v_cvt_pk_bf16_f32 v169, v170, v171
    v_cvt_pk_bf16_f32 v170, v172, v173
    v_pk_mul_f32 v[176:177], v[176:177], v[116:117] op_sel_hi:[1,0]
    v_pk_mul_f32 v[178:179], v[178:179], v[116:117] op_sel_hi:[1,0]
    v_pk_mul_f32 v[180:181], v[180:181], v[116:117] op_sel_hi:[1,0]
    v_pk_mul_f32 v[182:183], v[182:183], v[116:117] op_sel_hi:[1,0]
    v_pk_mul_f32 v[184:185], v[184:185], v[116:117] op_sel_hi:[1,0]
    v_pk_mul_f32 v[186:187], v[186:187], v[116:117] op_sel_hi:[1,0]
    v_pk_mul_f32 v[188:189], v[188:189], v[116:117] op_sel_hi:[1,0]
    v_pk_mul_f32 v[190:191], v[190:191], v[116:117] op_sel_hi:[1,0]
    v_cvt_pk_bf16_f32 v171, v174, v175
    v_permlane16_swap_b32 v168, v170
    v_cvt_pk_bf16_f32 v176, v176, v177
    v_permlane16_swap_b32 v169, v171
    v_cvt_pk_bf16_f32 v177, v178, v179
    v_cvt_pk_bf16_f32 v178, v180, v181
    v_cvt_pk_bf16_f32 v179, v182, v183
    v_cvt_pk_bf16_f32 v184, v184, v185
    v_permlane16_swap_b32 v176, v178
    v_permlane16_swap_b32 v177, v179
    v_cvt_pk_bf16_f32 v185, v186, v187
    v_cvt_pk_bf16_f32 v186, v188, v189
    v_cvt_pk_bf16_f32 v187, v190, v191
    v_mfma_f32_16x16x32_bf16 v[200:203], a[148:151], a[168:171], v[200:203]
    v_permlane16_swap_b32 v184, v186
    v_permlane16_swap_b32 v185, v187
    v_mfma_f32_16x16x32_bf16 v[204:207], a[152:155], v[60:63], v[204:207]
    buffer_store_dwordx4 v[168:171], v22, s[20:23], s96 offen offset:64 sc0 sc1 nt
    v_mfma_f32_16x16x32_bf16 v[204:207], a[156:159], a[168:171], v[204:207]
    ds_write_b32 v21, v28 offset:8
    v_mfma_f32_16x16x32_bf16 v[208:211], a[0:3], v[60:63], v[208:211]
    v_cvt_pk_bf16_f32 v83, v122, v123
    v_mfma_f32_16x16x32_bf16 v[208:211], a[4:7], a[168:171], v[208:211]
    ds_write_b128 v12, v[80:83] offset:55808
    v_mfma_f32_16x16x32_bf16 v[212:215], a[8:11], v[60:63], v[212:215]
    v_mfma_f32_16x16x32_bf16 v[212:215], a[12:15], a[168:171], v[212:215]
    v_mfma_f32_16x16x32_bf16 v[216:219], a[16:19], v[60:63], v[216:219]
    v_mfma_f32_16x16x32_bf16 v[216:219], a[20:23], a[168:171], v[216:219]
    v_mfma_f32_16x16x32_bf16 v[220:223], a[24:27], v[60:63], v[220:223]
    v_mfma_f32_16x16x32_bf16 v[220:223], a[28:31], a[168:171], v[220:223]
    v_mfma_f32_16x16x32_bf16 v[192:195], a[32:35], v[80:83], v[192:195]
    v_mfma_f32_16x16x32_bf16 v[196:199], a[40:43], v[80:83], v[196:199]
    s_waitcnt lgkmcnt(0)
    s_barrier
    v_mfma_f32_16x16x32_bf16 v[200:203], a[48:51], v[80:83], v[200:203]
    ds_read_b128 a[188:191], v13 offset:55808
    v_mfma_f32_16x16x32_bf16 v[204:207], a[56:59], v[80:83], v[204:207]
    ds_read_b32 v121, v2 offset:8
    v_mfma_f32_16x16x32_bf16 v[208:211], a[64:67], v[80:83], v[208:211]
    buffer_store_dwordx4 v[176:179], v22, s[20:23], s97 offen offset:0 sc0 sc1 nt
    v_mfma_f32_16x16x32_bf16 v[212:215], a[72:75], v[80:83], v[212:215]
    ds_read_b64 v[90:91], v14 offset:57856
    v_mfma_f32_16x16x32_bf16 v[216:219], a[80:83], v[80:83], v[216:219]
    ds_read_b32 v109, v2 offset:1024
    v_mfma_f32_16x16x32_bf16 v[220:223], a[88:91], v[80:83], v[220:223]
    s_waitcnt lgkmcnt(3)
    ds_read_b32 v110, v3 offset:1024
    v_mfma_f32_16x16x32_bf16 v[192:195], a[36:39], a[188:191], v[192:195]
    s_waitcnt lgkmcnt(3)
    v_add_f32 v28, v28, v121
    s_nop 1
    v_mfma_f32_16x16x4_f32 v[120:123], v24, v28, 0
    ds_read_b32 v111, v23 offset:1024
    v_mfma_f32_16x16x32_bf16 v[196:199], a[44:47], a[188:191], v[196:199]
    s_waitcnt lgkmcnt(2)
    v_add_f32 v30, v30, v109
    v_mfma_f32_16x16x32_bf16 v[200:203], a[52:55], a[188:191], v[200:203]
    v_mfma_f32_16x16x32_bf16 v[204:207], a[60:63], a[188:191], v[204:207]
    v_mfma_f32_16x16x32_bf16 v[208:211], a[68:71], a[188:191], v[208:211]
    v_mfma_f32_16x16x32_bf16 v[212:215], a[76:79], a[188:191], v[212:215]
    s_waitcnt lgkmcnt(0)
    v_add_f32 v110, v110, v111
    v_add_f32 v30, v30, v110
    v_mfma_f32_16x16x32_bf16 v[216:219], a[84:87], a[188:191], v[216:219]
    v_rcp_f32 v120, v120
    s_nop 0
    v_pk_mul_f32 v[192:193], v[192:193], v[120:121] op_sel_hi:[1,0]
    v_pk_mul_f32 v[194:195], v[194:195], v[120:121] op_sel_hi:[1,0]
    v_pk_mul_f32 v[196:197], v[196:197], v[120:121] op_sel_hi:[1,0]
    v_pk_mul_f32 v[198:199], v[198:199], v[120:121] op_sel_hi:[1,0]
    v_pk_mul_f32 v[200:201], v[200:201], v[120:121] op_sel_hi:[1,0]
    v_pk_mul_f32 v[202:203], v[202:203], v[120:121] op_sel_hi:[1,0]
    v_pk_mul_f32 v[204:205], v[204:205], v[120:121] op_sel_hi:[1,0]
    v_pk_mul_f32 v[206:207], v[206:207], v[120:121] op_sel_hi:[1,0]
    v_mfma_f32_16x16x32_bf16 v[220:223], a[92:95], a[188:191], v[220:223]
    buffer_store_dwordx4 v[184:187], v22, s[20:23], s97 offen offset:64 sc0 sc1 nt
    v_cvt_pk_bf16_f32 v192, v192, v193
    v_cvt_pk_bf16_f32 v193, v194, v195
    v_cvt_pk_bf16_f32 v194, v196, v197
    v_cvt_pk_bf16_f32 v195, v198, v199
    v_cvt_pk_bf16_f32 v200, v200, v201
    v_permlane16_swap_b32 v192, v194
    v_permlane16_swap_b32 v193, v195
    v_pk_mul_f32 v[208:209], v[208:209], v[120:121] op_sel_hi:[1,0]
    v_pk_mul_f32 v[210:211], v[210:211], v[120:121] op_sel_hi:[1,0]
    v_pk_mul_f32 v[212:213], v[212:213], v[120:121] op_sel_hi:[1,0]
    v_pk_mul_f32 v[214:215], v[214:215], v[120:121] op_sel_hi:[1,0]
    v_pk_mul_f32 v[216:217], v[216:217], v[120:121] op_sel_hi:[1,0]
    v_pk_mul_f32 v[218:219], v[218:219], v[120:121] op_sel_hi:[1,0]
    v_pk_mul_f32 v[220:221], v[220:221], v[120:121] op_sel_hi:[1,0]
    v_pk_mul_f32 v[222:223], v[222:223], v[120:121] op_sel_hi:[1,0]
    v_cvt_pk_bf16_f32 v201, v202, v203
    v_cvt_pk_bf16_f32 v202, v204, v205
    v_cvt_pk_bf16_f32 v203, v206, v207
    v_cvt_pk_bf16_f32 v208, v208, v209
    v_permlane16_swap_b32 v200, v202
    v_permlane16_swap_b32 v201, v203
    v_cvt_pk_bf16_f32 v209, v210, v211
    v_cvt_pk_bf16_f32 v210, v212, v213
    v_cvt_pk_bf16_f32 v211, v214, v215
    v_cvt_pk_bf16_f32 v216, v216, v217
    v_permlane16_swap_b32 v208, v210
    v_permlane16_swap_b32 v209, v211
    v_cvt_pk_bf16_f32 v217, v218, v219
    v_cvt_pk_bf16_f32 v218, v220, v221
    v_cvt_pk_bf16_f32 v219, v222, v223
    v_mfma_f32_16x16x32_bf16 v[104:107], a[192:195], a[96:99], 0
    v_permlane16_swap_b32 v216, v218
    v_permlane16_swap_b32 v217, v219
    v_mfma_f32_16x16x32_bf16 v[104:107], a[196:199], a[100:103], v[104:107]
    v_mfma_f32_16x16x32_bf16 v[104:107], a[200:203], a[104:107], v[104:107]
    v_mfma_f32_16x16x32_bf16 v[104:107], a[204:207], a[108:111], v[104:107]
    ds_read_b64 a[204:205], v13 offset:57856
    v_mfma_f32_16x16x32_bf16 v[104:107], a[208:211], a[112:115], v[104:107]
    buffer_store_dwordx4 v[192:195], v22, s[20:23], s98 offen offset:0 sc0 sc1 nt
    v_mfma_f32_16x16x32_bf16 v[104:107], a[212:215], a[116:119], v[104:107]
    ds_read_b64 a[206:207], v15 offset:57856
    v_mfma_f32_16x16x32_bf16 v[104:107], a[216:219], a[120:123], v[104:107]
    v_mfma_f32_16x16x32_bf16 v[104:107], a[220:223], a[124:127], v[104:107]
    v_mfma_f32_16x16x32_bf16 v[124:127], a[224:227], a[96:99], 0
    v_mfma_f32_16x16x32_bf16 v[124:127], a[228:231], a[100:103], v[124:127]
    v_mfma_f32_16x16x32_bf16 v[124:127], a[232:235], a[104:107], v[124:127]
    v_mfma_f32_16x16x32_bf16 v[124:127], a[236:239], a[108:111], v[124:127]
    v_mfma_f32_16x16x32_bf16 v[124:127], a[240:243], a[112:115], v[124:127]
    v_mfma_f32_16x16x32_bf16 v[124:127], a[244:247], a[116:119], v[124:127]
    s_nop 1
    v_fma_f32 v104, v104, s29, -v34
    v_mfma_f32_16x16x32_bf16 v[124:127], a[248:251], a[120:123], v[124:127]
    v_fma_f32 v105, v105, s29, -v34
    v_fma_f32 v106, v106, s29, -v34
    v_mfma_f32_16x16x32_bf16 v[124:127], a[252:255], a[124:127], v[124:127]
    v_fma_f32 v107, v107, s29, -v34
    v_mfma_f32_16x16x4_f32 v[108:111], v24, v30, 0
    v_exp_f32 v104, v104
    v_exp_f32 v105, v105
    v_exp_f32 v106, v106
    v_mfma_f32_16x16x32_bf16 v[36:39], a[128:131], v[68:71], v[36:39]
    v_exp_f32 v107, v107
    v_mfma_f32_16x16x32_bf16 v[36:39], a[132:135], a[176:179], v[36:39]
    buffer_store_dwordx4 v[200:203], v22, s[20:23], s98 offen offset:64 sc0 sc1 nt
    v_mfma_f32_16x16x32_bf16 v[40:43], a[136:139], v[68:71], v[40:43]
    v_add_f32 v29, v29, v104
    v_add_f32 v29, v29, v105
    v_mfma_f32_16x16x32_bf16 v[40:43], a[140:143], a[176:179], v[40:43]
    v_cvt_pk_bf16_f32 v84, v104, v105
    v_add_f32 v29, v29, v106
    v_mfma_f32_16x16x32_bf16 v[44:47], a[144:147], v[68:71], v[44:47]
    v_add_f32 v29, v29, v107
    v_cvt_pk_bf16_f32 v85, v106, v107
    v_mfma_f32_16x16x32_bf16 v[44:47], a[148:151], a[176:179], v[44:47]
    v_fma_f32 v124, v124, s29, -v34
    v_fma_f32 v125, v125, s29, -v34
    v_mfma_f32_16x16x32_bf16 v[48:51], a[152:155], v[68:71], v[48:51]
    v_fma_f32 v126, v126, s29, -v34
    v_fma_f32 v127, v127, s29, -v34
    v_mfma_f32_16x16x32_bf16 v[48:51], a[156:159], a[176:179], v[48:51]
    v_exp_f32 v124, v124
    v_mfma_f32_16x16x32_bf16 v[36:39], a[32:35], v[88:91], v[36:39]
    s_waitcnt lgkmcnt(0)
    v_exp_f32 v125, v125
    v_mfma_f32_16x16x32_bf16 v[36:39], a[36:39], a[204:207], v[36:39]
    v_exp_f32 v126, v126
    v_mfma_f32_16x16x32_bf16 v[40:43], a[40:43], v[88:91], v[40:43]
    v_exp_f32 v127, v127
    v_mfma_f32_16x16x32_bf16 v[40:43], a[44:47], a[204:207], v[40:43]
    v_add_f32 v29, v29, v124
    v_add_f32 v29, v29, v125
    v_mfma_f32_16x16x32_bf16 v[44:47], a[48:51], v[88:91], v[44:47]
    v_cvt_pk_bf16_f32 v86, v124, v125
    v_add_f32 v29, v29, v126
    v_mfma_f32_16x16x32_bf16 v[44:47], a[52:55], a[204:207], v[44:47]
    v_add_f32 v29, v29, v127
    v_cvt_pk_bf16_f32 v87, v126, v127
    v_mfma_f32_16x16x32_bf16 v[48:51], a[56:59], v[88:91], v[48:51]
    ds_write_b128 v12, v[84:87] offset:56832
    v_mfma_f32_16x16x32_bf16 v[48:51], a[60:63], a[204:207], v[48:51]
    v_rcp_f32 v108, v108
    buffer_store_dwordx4 v[208:211], v22, s[20:23], s99 offen offset:0 sc0 sc1 nt
    v_mfma_f32_16x16x32_bf16 v[224:227], a[128:131], v[64:67], v[224:227]
    ds_write_b32 v21, v29 offset:12
    v_mfma_f32_16x16x32_bf16 v[224:227], a[132:135], a[172:175], v[224:227]
    v_pk_mul_f32 v[36:37], v[36:37], v[108:109] op_sel_hi:[1,0]
    v_pk_mul_f32 v[38:39], v[38:39], v[108:109] op_sel_hi:[1,0]
    v_pk_mul_f32 v[40:41], v[40:41], v[108:109] op_sel_hi:[1,0]
    v_pk_mul_f32 v[42:43], v[42:43], v[108:109] op_sel_hi:[1,0]
    v_pk_mul_f32 v[44:45], v[44:45], v[108:109] op_sel_hi:[1,0]
    v_pk_mul_f32 v[46:47], v[46:47], v[108:109] op_sel_hi:[1,0]
    v_pk_mul_f32 v[48:49], v[48:49], v[108:109] op_sel_hi:[1,0]
    v_pk_mul_f32 v[50:51], v[50:51], v[108:109] op_sel_hi:[1,0]
    v_mfma_f32_16x16x32_bf16 v[228:231], a[136:139], v[64:67], v[228:231]
    v_cvt_pk_bf16_f32 v36, v36, v37
    v_cvt_pk_bf16_f32 v37, v38, v39
    v_mfma_f32_16x16x32_bf16 v[228:231], a[140:143], a[172:175], v[228:231]
    ds_write_b64 v16, v[36:37] offset:0
    v_mfma_f32_16x16x32_bf16 v[232:235], a[144:147], v[64:67], v[232:235]
    v_cvt_pk_bf16_f32 v40, v40, v41
    v_cvt_pk_bf16_f32 v41, v42, v43
    v_mfma_f32_16x16x32_bf16 v[232:235], a[148:151], a[172:175], v[232:235]
    ds_write_b64 v16, v[40:41] offset:32
    v_mfma_f32_16x16x32_bf16 v[236:239], a[152:155], v[64:67], v[236:239]
    s_waitcnt lgkmcnt(2)
    s_barrier
    v_cvt_pk_bf16_f32 v44, v44, v45
    v_cvt_pk_bf16_f32 v45, v46, v47
    v_mfma_f32_16x16x32_bf16 v[236:239], a[156:159], a[172:175], v[236:239]
    ds_write_b64 v16, v[44:45] offset:64
    v_mfma_f32_16x16x32_bf16 v[240:243], a[0:3], v[64:67], v[240:243]
    v_cvt_pk_bf16_f32 v48, v48, v49
    v_cvt_pk_bf16_f32 v49, v50, v51
    v_mfma_f32_16x16x32_bf16 v[240:243], a[4:7], a[172:175], v[240:243]
    ds_write_b64 v16, v[48:49] offset:96
    v_mfma_f32_16x16x32_bf16 v[244:247], a[8:11], v[64:67], v[244:247]
    buffer_store_dwordx4 v[216:219], v22, s[20:23], s99 offen offset:64 sc0 sc1 nt
    v_mfma_f32_16x16x32_bf16 v[244:247], a[12:15], a[172:175], v[244:247]
    ds_read_b128 v[36:39], v18 offset:0
    v_mfma_f32_16x16x32_bf16 v[248:251], a[16:19], v[64:67], v[248:251]
    ds_read_b128 v[40:43], v18 offset:272
    v_mfma_f32_16x16x32_bf16 v[248:251], a[20:23], a[172:175], v[248:251]
    ds_read_b32 v125, v2 offset:12
    v_mfma_f32_16x16x32_bf16 v[252:255], a[24:27], v[64:67], v[252:255]
    ds_read_b128 v[92:95], v3 offset:0
    v_mfma_f32_16x16x32_bf16 v[252:255], a[28:31], a[172:175], v[252:255]
    ds_read_b128 v[96:99], v23 offset:0
    v_mfma_f32_16x16x32_bf16 v[224:227], a[32:35], v[84:87], v[224:227]
    ds_read_b128 a[208:211], v13 offset:56832
    v_mfma_f32_16x16x32_bf16 v[228:231], a[40:43], v[84:87], v[228:231]
    v_mfma_f32_16x16x32_bf16 v[232:235], a[48:51], v[84:87], v[232:235]
    v_mfma_f32_16x16x32_bf16 v[236:239], a[56:59], v[84:87], v[236:239]
    s_waitcnt lgkmcnt(3)
    v_add_f32 v29, v29, v125
    v_add_f32 v101, v28, v29
    s_nop 0
    v_mfma_f32_16x16x4_f32 v[124:127], v24, v29, 0
    s_waitcnt lgkmcnt(1)
    v_add_f32 v92, v92, v96
    v_add_f32 v93, v93, v97
    v_add_f32 v94, v94, v98
    v_add_f32 v95, v95, v99
    s_waitcnt lgkmcnt(0)
    v_mfma_f32_16x16x32_bf16 v[224:227], a[36:39], a[208:211], v[224:227]
    v_min3_f32 v97, v26, v27, v28
    v_min3_f32 v97, v97, v29, v30
    v_mfma_f32_16x16x32_bf16 v[228:231], a[44:47], a[208:211], v[228:231]
    v_min3_f32 v97, v97, v92, v93
    v_min3_f32 v97, v97, v94, v95
    v_mfma_f32_16x16x32_bf16 v[232:235], a[52:55], a[208:211], v[232:235]
    v_add_f32 v96, v26, v27
    v_add_f32 v100, v92, v93
    v_mfma_f32_16x16x32_bf16 v[236:239], a[60:63], a[208:211], v[236:239]
    v_add_f32 v102, v94, v95
    v_add_f32 v96, v96, v101
    v_mfma_f32_16x16x32_bf16 v[240:243], a[64:67], v[84:87], v[240:243]
    v_add_f32 v100, v100, v102
    v_add_f32 v96, v96, v100
    v_mfma_f32_16x16x32_bf16 v[240:243], a[68:71], a[208:211], v[240:243]
    v_add_f32 v96, v96, v30
    v_cmp_nle_f32 s[42:43], s51, v97
    v_mfma_f32_16x16x32_bf16 v[244:247], a[72:75], v[84:87], v[244:247]
    v_cmp_nge_f32 vcc, s50, v96
    v_mfma_f32_16x16x32_bf16 v[244:247], a[76:79], a[208:211], v[244:247]
    v_rcp_f32 v124, v124
    s_nop 0
    v_pk_mul_f32 v[224:225], v[224:225], v[124:125] op_sel_hi:[1,0]
    v_pk_mul_f32 v[226:227], v[226:227], v[124:125] op_sel_hi:[1,0]
    v_pk_mul_f32 v[228:229], v[228:229], v[124:125] op_sel_hi:[1,0]
    v_pk_mul_f32 v[230:231], v[230:231], v[124:125] op_sel_hi:[1,0]
    v_pk_mul_f32 v[232:233], v[232:233], v[124:125] op_sel_hi:[1,0]
    v_pk_mul_f32 v[234:235], v[234:235], v[124:125] op_sel_hi:[1,0]
    v_pk_mul_f32 v[236:237], v[236:237], v[124:125] op_sel_hi:[1,0]
    v_pk_mul_f32 v[238:239], v[238:239], v[124:125] op_sel_hi:[1,0]
    v_mfma_f32_16x16x32_bf16 v[248:251], a[80:83], v[84:87], v[248:251]
    v_cvt_pk_bf16_f32 v224, v224, v225
    v_cvt_pk_bf16_f32 v225, v226, v227
    v_mfma_f32_16x16x32_bf16 v[248:251], a[84:87], a[208:211], v[248:251]
    v_cvt_pk_bf16_f32 v228, v228, v229
    v_cvt_pk_bf16_f32 v229, v230, v231
    v_mfma_f32_16x16x32_bf16 v[252:255], a[88:91], v[84:87], v[252:255]
    v_cvt_pk_bf16_f32 v232, v232, v233
    v_cvt_pk_bf16_f32 v233, v234, v235
    v_mfma_f32_16x16x32_bf16 v[252:255], a[92:95], a[208:211], v[252:255]
    ds_write_b64 v16, v[224:225] offset:0
    v_cvt_pk_bf16_f32 v236, v236, v237
    v_cvt_pk_bf16_f32 v237, v238, v239
    ds_write_b64 v16, v[228:229] offset:32
    ds_write_b64 v16, v[232:233] offset:64
    ds_write_b64 v16, v[236:237] offset:96
    buffer_store_dwordx4 v[36:39], v20, s[20:23], 0 offen offset:0 sc0 sc1 nt
    v_pk_mul_f32 v[240:241], v[240:241], v[124:125] op_sel_hi:[1,0]
    v_pk_mul_f32 v[242:243], v[242:243], v[124:125] op_sel_hi:[1,0]
    v_pk_mul_f32 v[244:245], v[244:245], v[124:125] op_sel_hi:[1,0]
    v_pk_mul_f32 v[246:247], v[246:247], v[124:125] op_sel_hi:[1,0]
    v_pk_mul_f32 v[248:249], v[248:249], v[124:125] op_sel_hi:[1,0]
    v_pk_mul_f32 v[250:251], v[250:251], v[124:125] op_sel_hi:[1,0]
    v_pk_mul_f32 v[252:253], v[252:253], v[124:125] op_sel_hi:[1,0]
    v_pk_mul_f32 v[254:255], v[254:255], v[124:125] op_sel_hi:[1,0]
    v_cvt_pk_bf16_f32 v240, v240, v241
    v_cvt_pk_bf16_f32 v241, v242, v243
    ds_write_b64 v16, v[240:241] offset:128
    v_cvt_pk_bf16_f32 v244, v244, v245
    v_cvt_pk_bf16_f32 v245, v246, v247
    ds_write_b64 v16, v[244:245] offset:160
    buffer_store_dwordx4 v[40:43], v20, s[20:23], 0 offen offset:512 sc0 sc1 nt
    v_cvt_pk_bf16_f32 v248, v248, v249
    v_cvt_pk_bf16_f32 v249, v250, v251
    ds_write_b64 v16, v[248:249] offset:192
    v_cvt_pk_bf16_f32 v252, v252, v253
    v_cvt_pk_bf16_f32 v253, v254, v255
    ds_write_b64 v16, v[252:253] offset:224
    ds_read_b128 v[224:227], v17 offset:0
    ds_read_b128 v[228:231], v17 offset:272
    ds_read_b128 v[232:235], v17 offset:544
    ds_read_b128 v[236:239], v17 offset:816
    s_waitcnt lgkmcnt(3)
    buffer_store_dwordx4 v[224:227], v19, s[20:23], s93 offen offset:0 sc0 sc1 nt
    s_waitcnt lgkmcnt(2)
    buffer_store_dwordx4 v[228:231], v19, s[20:23], s93 offen offset:512 sc0 sc1 nt
    s_waitcnt lgkmcnt(1)
    buffer_store_dwordx4 v[232:235], v19, s[20:23], s93 offen offset:1024 sc0 sc1 nt
    s_waitcnt lgkmcnt(0)
    buffer_store_dwordx4 v[236:239], v19, s[20:23], s93 offen offset:1536 sc0 sc1 nt
    s_nop 1
    s_or_b64 s[42:43], s[42:43], vcc
    s_cselect_b32 s40, 1, 0
    s_cmp_gt_u32 s40, s30
    s_cbranch_scc1 L_fallback
L_end:
    s_endpgm
L_codeend:
L_fallback:
    s_waitcnt vmcnt(0) lgkmcnt(0)
    s_barrier
    v_mbcnt_lo_u32_b32 v22, -1, 0
    v_mbcnt_hi_u32_b32 v22, -1, v22
    v_lshlrev_b32 v2, 4, v22
    v_bfe_u32 v92, v22, 2, 1
    v_bfe_u32 v93, v22, 3, 1
    v_lshl_add_u32 v92, v92, 1, v93
    v_and_b32 v93, 3, v22
    v_lshl_add_u32 v97, v93, 2, v92
    v_lshrrev_b32 v94, 4, v22
    v_mul_u32_u24 v96, 1040, v97
    v_lshl_add_u32 v96, v94, 7, v96
    s_mul_i32 s40, s33, 16640
    s_lshl_b32 s41, s32, 9
    s_xor_b32 s42, s41, 512
    s_sub_u32 s43, 16640, s40
    s_add_u32 s44, s40, s41
    s_add_u32 s45, s40, s42
    s_add_u32 s46, s43, s41
    s_add_u32 s47, s43, s42
    v_add_u32 v96, 87040, v96
    v_add_u32 v0, s44, v96
    v_add_u32 v1, s45, v96
    s_add_u32 s87, s86, 8192
    s_mov_b32 s91, 8192
    s_add_u32 s88, s86, 16384
    s_mov_b32 s92, 16384
    s_add_u32 s89, s86, 24576
    s_mov_b32 s93, 24576
    s_lshl_b32 s90, s24, 11
    s_add_u32 s90, s90, 65536
    s_lshr_b32 s85, s84, 1
    v_and_b32 v92, 7, v22
    v_bfe_u32 v95, v22, 3, 1
    v_lshl_add_u32 v97, v92, 1, v95
    v_mul_u32_u24 v99, 1040, v92
    v_lshl_add_u32 v99, v95, 9, v99
    v_lshl_add_u32 v99, v94, 7, v99
    s_mul_i32 s40, s32, 8320
    s_add_u32 s40, s40, 20480
    v_add_u32 v23, s40, v99
    v_add_u32 v24, 0, v99
    v_bfe_u32 v92, v22, 4, 1
    v_bfe_u32 v95, v22, 5, 1
    v_lshl_add_u32 v92, v92, 1, v95
    v_and_b32 v95, 12, v22
    v_add_u32 v92, v92, v95
    v_mul_u32_u24 v95, 1040, v92
    v_lshl_add_u32 v95, v93, 3, v95
    s_lshl_b32 s40, s34, 8
    s_add_u32 s40, s40, 20480
    v_add_u32 v95, s40, v95
    s_lshl_b32 s40, s32, 7
    s_xor_b32 s41, s40, 128
    v_add_u32 v100, s40, v95
    v_add_u32 v101, s41, v95
    v_add_u32 v4, s44, v100
    v_add_u32 v5, s44, v101
    v_add_u32 v6, s45, v100
    v_add_u32 v7, s45, v101
    v_add_u32 v8, s46, v100
    v_add_u32 v9, s46, v101
    v_add_u32 v10, s47, v100
    v_add_u32 v11, s47, v101
    s_xor_b32 s40, s24, 0
    s_mul_i32 s25, s40, 5120
    v_lshl_add_u32 v12, v22, 2, s25
    s_xor_b32 s40, s24, 1
    s_mul_i32 s57, s40, 5120
    v_lshl_add_u32 v13, v22, 2, s57
    s_xor_b32 s40, s24, 2
    s_mul_i32 s58, s40, 5120
    v_lshl_add_u32 v14, v22, 2, s58
    s_xor_b32 s40, s24, 3
    s_mul_i32 s59, s40, 5120
    v_lshl_add_u32 v15, v22, 2, s59
    s_mul_i32 s40, s24, 4352
    s_add_u32 s40, s40, 120320
    v_mul_u32_u24 v16, 272, v97
    v_lshl_add_u32 v16, v94, 3, v16
    v_add_u32 v16, s40, v16
    v_and_b32 v93, 15, v22
    v_lshlrev_b32 v93, 4, v93
    v_mul_u32_u24 v17, 1088, v94
    v_add3_u32 v17, v17, v93, s40
    s_lshl_b32 s41, s32, 15
    s_lshl_b32 s42, s34, 8
    s_add_u32 s41, s41, s42
    s_lshl_b32 s43, s32, 7
    v_xor_b32 v93, s43, v93
    v_lshl_add_u32 v19, v94, 11, v93
    v_add_u32 v19, s41, v19
    v_lshrrev_b32 v92, 3, v22
    v_and_b32 v93, 7, v22
    v_lshlrev_b32 v93, 4, v93
    v_mul_u32_u24 v18, 544, v92
    v_add3_u32 v18, v18, v93, s40
    s_lshl_b32 s41, s32, 7
    s_add_u32 s41, s41, s42
    s_add_u32 s41, s41, 65536
    v_lshl_add_u32 v20, v92, 10, v93
    v_add_u32 v20, s41, v20
    s_mov_b32 s50, 0x53800000
    s_mov_b32 s51, 0x2b800000
    s_bfe_u32 s40, s2, 0x20003
    s_lshl_b32 s40, s40, 2
    s_add_u32 s40, s40, s24
    s_mul_i32 s40, s40, 1024
    v_lshrrev_b32 v3, 3, v22
    v_lshl_add_u32 v3, v3, 7, s40
    s_lshl_b32 s40, s24, 11
    s_add_u32 s40, s40, 155648
    v_add_u32 v21, s40, v2
    s_lshl_b32 s40, s32, 15
    s_lshl_b32 s41, s34, 8
    s_add_u32 s40, s40, s41
    s_lshl_b32 s41, s32, 7
    s_add_u32 s94, s40, s41
    s_xor_b32 s95, s94, 128
    s_add_u32 s96, s94, 8192
    s_add_u32 s97, s95, 8192
    s_add_u32 s98, s96, 8192
    s_add_u32 s99, s97, 8192
    s_add_u32 s100, s98, 8192
    s_add_u32 s101, s99, 8192
    v_bfe_u32 v92, v22, 4, 1
    v_lshrrev_b32 v93, 5, v22
    v_lshlrev_b32 v92, 5, v92
    v_lshl_add_u32 v92, v93, 4, v92
    v_lshl_add_u32 v22, v97, 9, v92
    s_add_u32 m0, s84, 20480
    s_nop 0
    buffer_load_dwordx4 v2, s[8:11], s86 offen offset:0 nt lds
    s_add_u32 m0, s84, 20496
    s_nop 0
    buffer_load_dwordx4 v2, s[8:11], s86 offen offset:1024 nt lds
    s_add_u32 m0, s84, 20512
    s_nop 0
    buffer_load_dwordx4 v2, s[8:11], s86 offen offset:2048 nt lds
    s_add_u32 m0, s84, 20528
    s_nop 0
    buffer_load_dwordx4 v2, s[8:11], s86 offen offset:3072 nt lds
    s_add_u32 m0, s84, 37120
    s_nop 0
    buffer_load_dwordx4 v2, s[8:11], s87 offen offset:0 nt lds
    s_add_u32 m0, s84, 37136
    s_nop 0
    buffer_load_dwordx4 v2, s[8:11], s87 offen offset:1024 nt lds
    s_add_u32 m0, s84, 37152
    s_nop 0
    buffer_load_dwordx4 v2, s[8:11], s87 offen offset:2048 nt lds
    s_add_u32 m0, s84, 37168
    s_nop 0
    buffer_load_dwordx4 v2, s[8:11], s87 offen offset:3072 nt lds
    s_add_u32 m0, s84, 53760
    s_nop 0
    buffer_load_dwordx4 v2, s[8:11], s88 offen offset:0 nt lds
    s_add_u32 m0, s84, 53776
    s_nop 0
    buffer_load_dwordx4 v2, s[8:11], s88 offen offset:1024 nt lds
    s_add_u32 m0, s84, 53792
    s_nop 0
    buffer_load_dwordx4 v2, s[8:11], s88 offen offset:2048 nt lds
    s_add_u32 m0, s84, 53808
    s_nop 0
    buffer_load_dwordx4 v2, s[8:11], s88 offen offset:3072 nt lds
    s_add_u32 m0, s84, 70400
    s_nop 0
    buffer_load_dwordx4 v2, s[8:11], s89 offen offset:0 nt lds
    s_add_u32 m0, s84, 70416
    s_nop 0
    buffer_load_dwordx4 v2, s[8:11], s89 offen offset:1024 nt lds
    s_add_u32 m0, s84, 70432
    s_nop 0
    buffer_load_dwordx4 v2, s[8:11], s89 offen offset:2048 nt lds
    s_add_u32 m0, s84, 70448
    s_nop 0
    buffer_load_dwordx4 v2, s[8:11], s89 offen offset:3072 nt lds
    s_add_u32 m0, s85, 0
    s_nop 0
    buffer_load_dwordx4 v2, s[8:11], s90 offen offset:0 nt lds
    s_add_u32 m0, s85, 16
    s_nop 0
    buffer_load_dwordx4 v2, s[8:11], s90 offen offset:1024 nt lds
    s_waitcnt vmcnt(0)
    s_barrier
    ds_read_b128 a[0:3], v23 offset:0
    ds_read_b128 a[4:7], v23 offset:16
    ds_read_b128 a[8:11], v23 offset:32
    ds_read_b128 a[12:15], v23 offset:48
    ds_read_b128 a[16:19], v23 offset:64
    ds_read_b128 a[20:23], v23 offset:80
    ds_read_b128 a[24:27], v23 offset:96
    ds_read_b128 a[28:31], v23 offset:112
    ds_read_b128 a[32:35], v23 offset:16640
    ds_read_b128 a[36:39], v23 offset:16656
    ds_read_b128 a[40:43], v23 offset:16672
    ds_read_b128 a[44:47], v23 offset:16688
    ds_read_b128 a[48:51], v23 offset:16704
    ds_read_b128 a[52:55], v23 offset:16720
    ds_read_b128 a[56:59], v23 offset:16736
    ds_read_b128 a[60:63], v23 offset:16752
    ds_read_b128 a[64:67], v23 offset:33280
    ds_read_b128 a[68:71], v23 offset:33296
    ds_read_b128 a[72:75], v23 offset:33312
    ds_read_b128 a[76:79], v23 offset:33328
    ds_read_b128 a[80:83], v23 offset:33344
    ds_read_b128 a[84:87], v23 offset:33360
    ds_read_b128 a[88:91], v23 offset:33376
    ds_read_b128 a[92:95], v23 offset:33392
    ds_read_b128 a[96:99], v23 offset:49920
    ds_read_b128 a[100:103], v23 offset:49936
    ds_read_b128 a[104:107], v23 offset:49952
    ds_read_b128 a[108:111], v23 offset:49968
    ds_read_b128 a[112:115], v23 offset:49984
    ds_read_b128 a[116:119], v23 offset:50000
    ds_read_b128 a[120:123], v23 offset:50016
    ds_read_b128 a[124:127], v23 offset:50032
    ds_read_b128 a[128:131], v24 offset:0
    ds_read_b128 a[132:135], v24 offset:16
    ds_read_b128 a[136:139], v24 offset:32
    ds_read_b128 a[140:143], v24 offset:48
    ds_read_b128 a[144:147], v24 offset:64
    ds_read_b128 a[148:151], v24 offset:80
    ds_read_b128 a[152:155], v24 offset:96
    ds_read_b128 a[156:159], v24 offset:112
    v_mov_b32 v31, 0xff800000
    v_mov_b32 v32, 0xff800000
    v_mov_b32 v33, 0xff800000
    v_mov_b32 v34, 0xff800000
    v_mov_b32 v35, 0xff800000
    s_lshl_b32 s40, s24, 13
    s_add_u32 s40, s40, 4096
    s_add_u32 s14, s12, s40
    s_addc_u32 s15, s13, 0
    s_mov_b32 s28, 16
L_fb_loop:
    s_waitcnt vmcnt(0) lgkmcnt(0)
    s_barrier
    s_add_u32 m0, s31, 91136
    s_nop 0
    global_load_lds_dwordx4 v2, s[14:15] offset:-4096 nt
    s_add_u32 m0, s31, 91152
    s_nop 0
    global_load_lds_dwordx4 v2, s[14:15] offset:-3072 nt
    s_add_u32 m0, s31, 91168
    s_nop 0
    global_load_lds_dwordx4 v2, s[14:15] offset:-2048 nt
    s_add_u32 m0, s31, 91184
    s_nop 0
    global_load_lds_dwordx4 v2, s[14:15] offset:-1024 nt
    s_add_u32 m0, s31, 91200
    s_nop 0
    global_load_lds_dwordx4 v2, s[14:15] offset:0 nt
    s_add_u32 m0, s31, 91216
    s_nop 0
    global_load_lds_dwordx4 v2, s[14:15] offset:1024 nt
    s_add_u32 m0, s31, 91232
    s_nop 0
    global_load_lds_dwordx4 v2, s[14:15] offset:2048 nt
    s_add_u32 m0, s31, 91248
    s_nop 0
    global_load_lds_dwordx4 v2, s[14:15] offset:3072 nt
    s_add_u32 s14, s14, 32768
    s_addc_u32 s15, s15, 0
    s_waitcnt vmcnt(0)
    s_barrier
    ds_read_b128 a[192:195], v0 offset:0
    ds_read_b128 a[196:199], v0 offset:16
    ds_read_b128 a[200:203], v0 offset:32
    ds_read_b128 a[204:207], v0 offset:48
    ds_read_b128 a[208:211], v0 offset:64
    ds_read_b128 a[212:215], v0 offset:80
    ds_read_b128 a[216:219], v0 offset:96
    ds_read_b128 a[220:223], v0 offset:112
    ds_read_b128 a[224:227], v1 offset:0
    ds_read_b128 a[228:231], v1 offset:16
    ds_read_b128 a[232:235], v1 offset:32
    ds_read_b128 a[236:239], v1 offset:48
    ds_read_b128 a[240:243], v1 offset:64
    ds_read_b128 a[244:247], v1 offset:80
    ds_read_b128 a[248:251], v1 offset:96
    ds_read_b128 a[252:255], v1 offset:112
    s_waitcnt lgkmcnt(0)
    v_mfma_f32_16x16x32_bf16 v[92:95], a[192:195], a[0:3], 0
    v_mfma_f32_16x16x32_bf16 v[92:95], a[196:199], a[4:7], v[92:95]
    v_mfma_f32_16x16x32_bf16 v[92:95], a[200:203], a[8:11], v[92:95]
    v_mfma_f32_16x16x32_bf16 v[92:95], a[204:207], a[12:15], v[92:95]
    v_mfma_f32_16x16x32_bf16 v[92:95], a[208:211], a[16:19], v[92:95]
    v_mfma_f32_16x16x32_bf16 v[92:95], a[212:215], a[20:23], v[92:95]
    v_mfma_f32_16x16x32_bf16 v[92:95], a[216:219], a[24:27], v[92:95]
    v_mfma_f32_16x16x32_bf16 v[92:95], a[220:223], a[28:31], v[92:95]
    v_mfma_f32_16x16x32_bf16 v[96:99], a[192:195], a[32:35], 0
    v_mfma_f32_16x16x32_bf16 v[96:99], a[196:199], a[36:39], v[96:99]
    v_mfma_f32_16x16x32_bf16 v[96:99], a[200:203], a[40:43], v[96:99]
    v_mfma_f32_16x16x32_bf16 v[96:99], a[204:207], a[44:47], v[96:99]
    v_mfma_f32_16x16x32_bf16 v[96:99], a[208:211], a[48:51], v[96:99]
    v_mfma_f32_16x16x32_bf16 v[96:99], a[212:215], a[52:55], v[96:99]
    v_mfma_f32_16x16x32_bf16 v[96:99], a[216:219], a[56:59], v[96:99]
    v_mfma_f32_16x16x32_bf16 v[96:99], a[220:223], a[60:63], v[96:99]
    v_mfma_f32_16x16x32_bf16 v[100:103], a[192:195], a[64:67], 0
    v_mfma_f32_16x16x32_bf16 v[100:103], a[196:199], a[68:71], v[100:103]
    v_mfma_f32_16x16x32_bf16 v[100:103], a[200:203], a[72:75], v[100:103]
    v_mfma_f32_16x16x32_bf16 v[100:103], a[204:207], a[76:79], v[100:103]
    v_mfma_f32_16x16x32_bf16 v[100:103], a[208:211], a[80:83], v[100:103]
    v_mfma_f32_16x16x32_bf16 v[100:103], a[212:215], a[84:87], v[100:103]
    v_mfma_f32_16x16x32_bf16 v[100:103], a[216:219], a[88:91], v[100:103]
    v_mfma_f32_16x16x32_bf16 v[100:103], a[220:223], a[92:95], v[100:103]
    v_mfma_f32_16x16x32_bf16 v[104:107], a[192:195], a[96:99], 0
    v_mfma_f32_16x16x32_bf16 v[104:107], a[196:199], a[100:103], v[104:107]
    v_mfma_f32_16x16x32_bf16 v[104:107], a[200:203], a[104:107], v[104:107]
    v_mfma_f32_16x16x32_bf16 v[104:107], a[204:207], a[108:111], v[104:107]
    v_mfma_f32_16x16x32_bf16 v[104:107], a[208:211], a[112:115], v[104:107]
    v_mfma_f32_16x16x32_bf16 v[104:107], a[212:215], a[116:119], v[104:107]
    v_mfma_f32_16x16x32_bf16 v[104:107], a[216:219], a[120:123], v[104:107]
    v_mfma_f32_16x16x32_bf16 v[104:107], a[220:223], a[124:127], v[104:107]
    v_mfma_f32_16x16x32_bf16 v[108:111], a[192:195], a[128:131], 0
    v_mfma_f32_16x16x32_bf16 v[108:111], a[196:199], a[132:135], v[108:111]
    v_mfma_f32_16x16x32_bf16 v[108:111], a[200:203], a[136:139], v[108:111]
    v_mfma_f32_16x16x32_bf16 v[108:111], a[204:207], a[140:143], v[108:111]
    v_mfma_f32_16x16x32_bf16 v[108:111], a[208:211], a[144:147], v[108:111]
    v_mfma_f32_16x16x32_bf16 v[108:111], a[212:215], a[148:151], v[108:111]
    v_mfma_f32_16x16x32_bf16 v[108:111], a[216:219], a[152:155], v[108:111]
    v_mfma_f32_16x16x32_bf16 v[108:111], a[220:223], a[156:159], v[108:111]
    v_mfma_f32_16x16x32_bf16 v[112:115], a[224:227], a[0:3], 0
    v_mfma_f32_16x16x32_bf16 v[112:115], a[228:231], a[4:7], v[112:115]
    v_mfma_f32_16x16x32_bf16 v[112:115], a[232:235], a[8:11], v[112:115]
    v_mfma_f32_16x16x32_bf16 v[112:115], a[236:239], a[12:15], v[112:115]
    v_mfma_f32_16x16x32_bf16 v[112:115], a[240:243], a[16:19], v[112:115]
    v_mfma_f32_16x16x32_bf16 v[112:115], a[244:247], a[20:23], v[112:115]
    v_mfma_f32_16x16x32_bf16 v[112:115], a[248:251], a[24:27], v[112:115]
    v_mfma_f32_16x16x32_bf16 v[112:115], a[252:255], a[28:31], v[112:115]
    v_mfma_f32_16x16x32_bf16 v[116:119], a[224:227], a[32:35], 0
    v_mfma_f32_16x16x32_bf16 v[116:119], a[228:231], a[36:39], v[116:119]
    v_mfma_f32_16x16x32_bf16 v[116:119], a[232:235], a[40:43], v[116:119]
    v_mfma_f32_16x16x32_bf16 v[116:119], a[236:239], a[44:47], v[116:119]
    v_mfma_f32_16x16x32_bf16 v[116:119], a[240:243], a[48:51], v[116:119]
    v_mfma_f32_16x16x32_bf16 v[116:119], a[244:247], a[52:55], v[116:119]
    v_mfma_f32_16x16x32_bf16 v[116:119], a[248:251], a[56:59], v[116:119]
    v_mfma_f32_16x16x32_bf16 v[116:119], a[252:255], a[60:63], v[116:119]
    v_mfma_f32_16x16x32_bf16 v[120:123], a[224:227], a[64:67], 0
    v_mfma_f32_16x16x32_bf16 v[120:123], a[228:231], a[68:71], v[120:123]
    v_mfma_f32_16x16x32_bf16 v[120:123], a[232:235], a[72:75], v[120:123]
    v_mfma_f32_16x16x32_bf16 v[120:123], a[236:239], a[76:79], v[120:123]
    v_mfma_f32_16x16x32_bf16 v[120:123], a[240:243], a[80:83], v[120:123]
    v_mfma_f32_16x16x32_bf16 v[120:123], a[244:247], a[84:87], v[120:123]
    v_mfma_f32_16x16x32_bf16 v[120:123], a[248:251], a[88:91], v[120:123]
    v_mfma_f32_16x16x32_bf16 v[120:123], a[252:255], a[92:95], v[120:123]
    v_mfma_f32_16x16x32_bf16 v[124:127], a[224:227], a[96:99], 0
    v_mfma_f32_16x16x32_bf16 v[124:127], a[228:231], a[100:103], v[124:127]
    v_mfma_f32_16x16x32_bf16 v[124:127], a[232:235], a[104:107], v[124:127]
    v_mfma_f32_16x16x32_bf16 v[124:127], a[236:239], a[108:111], v[124:127]
    v_mfma_f32_16x16x32_bf16 v[124:127], a[240:243], a[112:115], v[124:127]
    v_mfma_f32_16x16x32_bf16 v[124:127], a[244:247], a[116:119], v[124:127]
    v_mfma_f32_16x16x32_bf16 v[124:127], a[248:251], a[120:123], v[124:127]
    v_mfma_f32_16x16x32_bf16 v[124:127], a[252:255], a[124:127], v[124:127]
    s_nop 7
    v_max3_f32 v31, v31, v92, v93
    v_max3_f32 v31, v31, v94, v95
    v_max3_f32 v32, v32, v96, v97
    v_max3_f32 v32, v32, v98, v99
    v_max3_f32 v33, v33, v100, v101
    v_max3_f32 v33, v33, v102, v103
    v_max3_f32 v34, v34, v104, v105
    v_max3_f32 v34, v34, v106, v107
    v_max3_f32 v35, v35, v108, v109
    v_max3_f32 v35, v35, v110, v111
    v_max3_f32 v31, v31, v112, v113
    v_max3_f32 v31, v31, v114, v115
    v_max3_f32 v32, v32, v116, v117
    v_max3_f32 v32, v32, v118, v119
    v_max3_f32 v33, v33, v120, v121
    v_max3_f32 v33, v33, v122, v123
    v_max3_f32 v34, v34, v124, v125
    v_max3_f32 v34, v34, v126, v127
    s_sub_u32 s28, s28, 1
    s_cmp_lg_u32 s28, 0
    s_cbranch_scc1 L_fb_loop
    v_mov_b32 v92, v31
    v_mov_b32 v93, v32
    v_mov_b32 v94, v33
    v_mov_b32 v95, v34
    v_mov_b32 v96, v35
    v_permlane32_swap_b32 v31, v92
    v_permlane32_swap_b32 v32, v93
    v_permlane32_swap_b32 v33, v94
    v_permlane32_swap_b32 v34, v95
    v_permlane32_swap_b32 v35, v96
    v_max_f32 v31, v31, v92
    v_max_f32 v32, v32, v93
    v_max_f32 v33, v33, v94
    v_max_f32 v34, v34, v95
    v_max_f32 v35, v35, v96
    v_mov_b32 v92, v31
    v_mov_b32 v93, v32
    v_mov_b32 v94, v33
    v_mov_b32 v95, v34
    v_mov_b32 v96, v35
    v_permlane16_swap_b32 v31, v92
    v_permlane16_swap_b32 v32, v93
    v_permlane16_swap_b32 v33, v94
    v_permlane16_swap_b32 v34, v95
    v_permlane16_swap_b32 v35, v96
    v_max_f32 v31, v31, v92
    v_max_f32 v32, v32, v93
    v_max_f32 v33, v33, v94
    v_max_f32 v34, v34, v95
    v_max_f32 v35, v35, v96
    v_mov_b32 v116, v31
    v_mov_b32 v117, v32
    v_mov_b32 v118, v33
    v_mov_b32 v119, v34
    ds_write_b128 v21, v[116:119] offset:0
    ds_write_b32 v21, v35 offset:1024
    s_waitcnt lgkmcnt(0)
    s_barrier
    v_xor_b32 v124, 2048, v21
    v_xor_b32 v125, 4096, v21
    v_xor_b32 v126, 6144, v21
    ds_read_b128 v[92:95], v124 offset:0
    ds_read_b32 v96, v124 offset:1024
    ds_read_b128 v[100:103], v125 offset:0
    ds_read_b32 v104, v125 offset:1024
    ds_read_b128 v[108:111], v126 offset:0
    ds_read_b32 v112, v126 offset:1024
    s_waitcnt lgkmcnt(5)
    v_max_f32 v31, v31, v92
    v_max_f32 v32, v32, v93
    v_max_f32 v33, v33, v94
    v_max_f32 v34, v34, v95
    s_waitcnt lgkmcnt(4)
    v_max_f32 v35, v35, v96
    s_waitcnt lgkmcnt(1)
    v_max_f32 v100, v100, v108
    v_max_f32 v101, v101, v109
    v_max_f32 v102, v102, v110
    v_max_f32 v103, v103, v111
    s_waitcnt lgkmcnt(0)
    v_max_f32 v104, v104, v112
    v_max_f32 v35, v35, v104
    v_mul_f32 v31, s29, v31
    v_mul_f32 v32, s29, v32
    v_mul_f32 v33, s29, v33
    v_mul_f32 v34, s29, v34
    v_mul_f32 v35, s29, v35
    s_mov_b32 s30, 1
    s_waitcnt vmcnt(0) lgkmcnt(0)
    s_barrier
    s_branch L_restart
.section .rodata,"a"
.p2align 6
.amdhsa_kernel standalone__gqa_softmax__near_ridge_kernel
  .amdhsa_next_free_vgpr 512
  .amdhsa_next_free_sgpr 102
  .amdhsa_accum_offset 256
  .amdhsa_group_segment_fixed_size 0
  .amdhsa_kernarg_size 48
  .amdhsa_user_sgpr_count 2
  .amdhsa_user_sgpr_kernarg_segment_ptr 1
  .amdhsa_system_sgpr_workgroup_id_x 1
.end_amdhsa_kernel
```
